```python
import torch

def _softmax(x, axis=-1):
    return torch.softmax(x, dim=axis)
def _gelu(x):
    return torch.nn.functional.gelu(x, approximate="tanh")
def _silu(x):
    return torch.nn.functional.silu(x)
def _sigmoid(x):
    return torch.sigmoid(x)
def _layernorm(x, axis=-1, eps=1e-5):
    m = x.mean(dim=axis, keepdim=True)
    v = x.var(dim=axis, keepdim=True, unbiased=False)
    return (x - m) / torch.sqrt(v + eps)
def _scatter_add(tgt, idx, src, axis=0):
    return tgt.clone().index_add_(axis, idx, src)
def _segment_sum(src, seg, n):
    out = torch.zeros((n,) + src.shape[1:], dtype=src.dtype)
    return out.index_add_(0, seg, src)
def _pad(x, pw):
    flat = tuple(v for pair in reversed(pw) for v in pair)
    return torch.nn.functional.pad(x, flat)

kernel_name = 'recurrent_scan__sliding_block__geglu_ffn__prompt'

def setup_inputs():

    _w = (lambda a: (lambda t: t.to(torch.bfloat16) if t.is_floating_point() else t)(torch.as_tensor(a)))
    def _A_setup():
        B, S, D = 1, 2048, 512
        return {
            "x": _w((lambda *s: torch.randn(*s, dtype=torch.bfloat16) * 0.05)(B, S, D)),
            "wqkv": _w((lambda *s: torch.randn(*s, dtype=torch.bfloat16) * 0.05)(D, 3 * D)),
            "wo": _w((lambda *s: torch.randn(*s, dtype=torch.bfloat16) * 0.05)(D, D)),
        }
    _A_in = _A_setup()

    def _B_setup():
        B, S, D, F = 1, 2048, 512, 1792
        return {
            "x": _w((lambda *s: torch.randn(*s, dtype=torch.bfloat16) * 0.05)(B, S, D)),
            "w_gate": _w((lambda *s: torch.randn(*s, dtype=torch.bfloat16) * 0.05)(D, F)),
            "w_up": _w((lambda *s: torch.randn(*s, dtype=torch.bfloat16) * 0.05)(D, F)),
            "w_down": _w((lambda *s: torch.randn(*s, dtype=torch.bfloat16) * 0.05)(F, D)),
        }
    _B_in = _B_setup()

    return {
        "A_x": _A_in["x"],
        "A_wqkv": _A_in["wqkv"],
        "A_wo": _A_in["wo"],
        "B_x": _B_in["x"],
        "B_w_gate": _B_in["w_gate"],
        "B_w_up": _B_in["w_up"],
        "B_w_down": _B_in["w_down"],
    }

def reference(A_x, A_wqkv, A_wo, B_x, B_w_gate, B_w_up, B_w_down):
    def _A_ref(x, wqkv, wo):
        B, S, D = x.shape
        H = 32; Dh = D // H; W = 256
        qkv = (lambda x, *d: x.permute(*d))((x @ wqkv).reshape(B, S, 3, H, Dh), 2, 0, 3, 1, 4)
        q, k, v = qkv[0], qkv[1], qkv[2]
        scores = torch.einsum("bhqd,bhkd->bhqk", q, k) * (Dh ** -0.5)
        idx = torch.arange(S)
        mask = (idx[:, None] - idx[None, :] >= 0) & (idx[:, None] - idx[None, :] < W)
        scores = torch.where(mask[None, None], scores, -1e9)
        p = _softmax(scores, axis=-1)
        o = torch.einsum("bhqk,bhkd->bhqd", p, v)
        return (lambda x, *d: x.permute(*d))(o, 0, 2, 1, 3).reshape(B, S, D) @ wo

    def _B_ref(x, w_gate, w_up, w_down):
        return (_gelu(x @ w_gate) * (x @ w_up)) @ w_down

    x = A_x
    xn = _layernorm(x, axis=-1)
    s = _A_ref(xn, A_wqkv, A_wo)
    g = _silu(_B_ref(xn, B_w_gate, B_w_up, B_w_down))
    return x + s * g
```

```asm
; @launch grid=(256,1,1) block=(512,1,1) lds=163840
.amdgcn_target "amdgcn-amd-amdhsa--gfx950"
.text
.globl recurrent_scan__sliding_block__geglu_ffn__prompt_kernel
.p2align 8
.type recurrent_scan__sliding_block__geglu_ffn__prompt_kernel,@function
recurrent_scan__sliding_block__geglu_ffn__prompt_kernel:
  s_load_dwordx4 s[4:7], s[0:1], 0
  s_load_dwordx4 s[8:11], s[0:1], 32
  s_load_dwordx4 s[16:19], s[0:1], 64
  s_getpc_b64 s[24:25]
L_PC0:
  v_and_b32 v16, 15, v0
  v_bfe_u32 v17, v0, 6, 2
  v_mul_u32_u24_e64 v17, 16, v17
  v_add_lshl_u32 v16, v16, v17, 7
  v_add_u32 v17, L_M-L_PC0, v16
  v_cmp_gt_u32 vcc, 256, v0
  s_mov_b64 exec, 65535
  s_nop 0
  v_cndmask_b32 v16, v16, v17, vcc
  global_load_dword v29, v16, s[24:25]
  s_mov_b64 exec, -1
  s_cmp_ge_u32 s2, 256
  s_cbranch_scc1 L_END
  v_and_b32 v1, 63, v0
  v_lshrrev_b32 v16, 6, v0
  s_and_b32 s57, s2, 7
  v_readfirstlane_b32 s14, v16
  s_lshr_b32 s58, s2, 3
  s_and_b32 s44, s57, 1
  s_and_b32 s45, s58, 7
  s_lshl_b32 s47, s44, 3
  s_add_u32 s47, s47, s45
  s_lshr_b32 s46, s57, 1
  s_lshr_b32 s49, s58, 3
  s_lshl_b32 s48, s46, 2
  s_add_u32 s48, s48, s49
  s_mul_i32 s51, s46, 3
  s_add_u32 s52, s51, s49
  s_lshl_b32 s53, s52, 1
  s_add_u32 s57, s46, 24
  s_add_u32 s54, s51, 12
  s_cmp_eq_u32 s49, 3
  s_cselect_b32 s50, 1, 0
  s_cselect_b32 s53, s57, s53
  s_cselect_b32 s54, s54, s52
  s_and_b32 s15, s14, 3
  s_cmp_lt_u32 s14, 4
  s_cbranch_scc1 L_M
  s_lshl_b32 s58, s15, 15
  v_lshrrev_b32 v16, 3, v1
  v_lshlrev_b32 v16, 10, v16
  v_add_u32 v16, s58, v16
  v_lshrrev_b32 v17, 4, v1
  v_xor_b32 v17, v17, v1
  v_and_b32 v17, 7, v17
  v_lshlrev_b32 v17, 4, v17
  v_add_u32 v7, v16, v17
  v_xor_b32_e64 v8, 64, v7
  s_lshl_b32 s12, s15, 12
  s_lshl_b32 s13, s15, 10
  s_lshl_b32 s57, s47, 17
  s_add_u32 s81, s49, s45
  s_lshl_b32 s81, s81, 2
  s_waitcnt lgkmcnt(0)
  s_add_u32 s72, s4, s57
  s_addc_u32 s73, s5, 0
  s_mov_b32 s74, 0x20000
  s_mov_b32 s75, 0x20000
  s_setprio 0
  s_add_u32 s56, s81, 0
  s_and_b32 s56, s56, 15
  s_lshl_b32 s56, s56, 6
  s_add_u32 m0, s12, 0
  s_add_u32 s59, s56, 0
  buffer_load_dwordx4 v7, s[72:75], s59 offen lds
  s_add_u32 m0, s12, 1024
  s_add_u32 s59, s56, 8192
  buffer_load_dwordx4 v8, s[72:75], s59 offen lds
  s_add_u32 m0, s12, 2048
  s_add_u32 s59, s56, 16384
  buffer_load_dwordx4 v7, s[72:75], s59 offen lds
  s_add_u32 m0, s12, 3072
  s_add_u32 s59, s56, 24576
  buffer_load_dwordx4 v8, s[72:75], s59 offen lds
  s_lshl_b32 s55, s53, 7
  s_lshl_b32 s56, s54, 7
  v_bfe_u32 v16, v1, 2, 3
  s_lshl_b32 s57, s15, 3
  v_add_u32 v16, s57, v16
  v_lshrrev_b32 v17, 5, v1
  v_lshlrev_b32 v17, 6, v17
  v_and_b32 v18, 3, v1
  v_lshlrev_b32 v18, 4, v18
  v_add_u32 v17, v17, v18
  s_lshl_b32 s66, s50, 5
  s_xor_b32 s67, s66, 32
  s_cmp_eq_u32 s50, 1
  s_movk_i32 s60, 3584
  s_add_u32 s24, s8, s55
  s_addc_u32 s25, s9, 0
  v_mul_u32_u24 v18, s60, v16
  v_add_u32 v2, v18, v17
  s_lshl_b32 s26, s60, 9
  s_mov_b32 s27, 0x20000
  s_cmp_eq_u32 s50, 1
  s_cselect_b32 s28, s10, s8
  s_cselect_b32 s29, s11, s9
  s_cselect_b32 s58, 0, 128
  s_movk_i32 s61, 3584
  s_add_u32 s57, s55, s58
  s_add_u32 s28, s28, s57
  s_addc_u32 s29, s29, 0
  v_mul_u32_u24 v18, s61, v16
  v_xor_b32 v19, s66, v17
  v_add_u32_e64 v3, v18, v19
  s_lshl_b32 s30, s61, 9
  s_mov_b32 s31, 0x20000
  s_cmp_eq_u32 s50, 1
  s_cselect_b32 s32, s6, s10
  s_cselect_b32 s33, s7, s11
  s_cselect_b32 s57, s56, s55
  s_movk_i32 s62, 3584
  s_cselect_b32 s62, 3072, s62
  s_add_u32 s32, s32, s57
  s_addc_u32 s33, s33, 0
  v_mul_u32_u24 v18, s62, v16
  v_xor_b32 v19, s67, v17
  v_add_u32_e64 v4, v18, v19
  s_lshl_b32 s34, s62, 9
  s_mov_b32 s35, 0x20000
  s_cmp_eq_u32 s50, 1
  s_cselect_b32 s36, s6, s10
  s_cselect_b32 s37, s7, s11
  s_cselect_b32 s57, s56, s55
  s_movk_i32 s63, 3584
  s_cselect_b32 s63, 3072, s63
  s_add_u32 s57, s57, 128
  s_add_u32 s36, s36, s57
  s_addc_u32 s37, s37, 0
  v_mul_u32_u24 v18, s63, v16
  v_xor_b32 v19, s67, v17
  v_add_u32_e64 v5, v18, v19
  s_lshl_b32 s38, s63, 9
  s_mov_b32 s39, 0x20000
  s_cmp_eq_u32 s50, 1
  s_cselect_b32 s58, 256, 0
  s_movk_i32 s64, 3072
  s_add_u32 s57, s56, s58
  s_add_u32 s40, s6, s57
  s_addc_u32 s41, s7, 0
  v_mul_u32_u24 v18, s64, v16
  v_add_u32 v6, v18, v17
  s_lshl_b32 s42, s64, 9
  s_mov_b32 s43, 0x20000
  s_add_u32 s56, s81, 0
  s_and_b32 s56, s56, 15
  s_lshl_b32 s56, s56, 5
  s_add_u32 m0, s13, 49152
  s_mul_i32 s59, s60, s56
  buffer_load_dwordx4 v2, s[24:27], s59 offen lds
  s_add_u32 m0, s13, 53248
  s_mul_i32 s59, s61, s56
  buffer_load_dwordx4 v3, s[28:31], s59 offen lds
  s_add_u32 m0, s13, 57344
  s_mul_i32 s59, s62, s56
  buffer_load_dwordx4 v4, s[32:35], s59 offen lds
  s_add_u32 m0, s13, 61440
  s_mul_i32 s59, s63, s56
  buffer_load_dwordx4 v5, s[36:39], s59 offen lds
  s_add_u32 m0, s13, 65536
  s_mul_i32 s59, s64, s56
  buffer_load_dwordx4 v6, s[40:43], s59 offen lds
  s_add_u32 s56, s81, 1
  s_and_b32 s56, s56, 15
  s_lshl_b32 s56, s56, 5
  s_add_u32 m0, s13, 69632
  s_mul_i32 s59, s60, s56
  buffer_load_dwordx4 v2, s[24:27], s59 offen lds
  s_add_u32 m0, s13, 73728
  s_mul_i32 s59, s61, s56
  buffer_load_dwordx4 v3, s[28:31], s59 offen lds
  s_add_u32 m0, s13, 77824
  s_mul_i32 s59, s62, s56
  buffer_load_dwordx4 v4, s[32:35], s59 offen lds
  s_add_u32 m0, s13, 81920
  s_mul_i32 s59, s63, s56
  buffer_load_dwordx4 v5, s[36:39], s59 offen lds
  s_add_u32 m0, s13, 86016
  s_mul_i32 s59, s64, s56
  buffer_load_dwordx4 v6, s[40:43], s59 offen lds
  s_mov_b32 s20, s18
  s_mov_b32 s21, s19
  s_mov_b32 s22, 0x10000000
  s_mov_b32 s23, 0x20000
  s_mov_b32 s18, 256
  s_mov_b32 s19, 0x20000
  s_or_b32 s57, s2, s15
  s_cmp_lg_u32 s57, 0
  s_cbranch_scc1 H_NONONCE
  s_memrealtime s[56:57]
  s_waitcnt lgkmcnt(0)
  s_mul_i32 s56, s56, 0x9e3779b1
  s_or_b32 s56, s56, 1
  v_mov_b32 v16, 0
  v_mov_b32_e64 v17, s56
  buffer_store_dword v17, v16, s[16:19], 0 offen sc1
H_NONONCE:
  s_lshl_b32 s69, s47, 5
  s_lshr_b32 s55, s45, 2
  s_lshl_b32 s57, s44, 1
  s_add_u32 s55, s55, s57
  v_lshrrev_b32 v16, 5, v1
  v_lshlrev_b32 v16, 10, v16
  v_bfe_u32 v17, v1, 2, 2
  v_lshlrev_b32 v17, 6, v17
  v_add_u32 v16, v16, v17
  v_and_b32 v17, 3, v1
  v_lshlrev_b32 v17, 3, v17
  v_add_u32_e64 v16, v16, v17
  v_bfe_u32 v17, v1, 4, 1
  v_lshlrev_b32 v17, 5, v17
  s_lshr_b32 s58, s15, 1
  s_lshl_b32 s58, s58, 12
  s_and_b32 s59, s15, 1
  s_lshl_b32 s59, s59, 9
  s_add_u32 s58, s58, s59
  v_add3_u32 v12, v16, v17, s58
  v_lshlrev_b32 v9, 4, v1
  v_mov_b32_e64 v10, 0
  s_waitcnt vmcnt(5)
  s_barrier
  s_add_u32 s56, s81, 2
  s_and_b32 s56, s56, 15
  s_lshl_b32 s56, s56, 6
  s_add_u32 m0, s12, 16384
  s_add_u32 s59, s56, 0
  buffer_load_dwordx4 v7, s[72:75], s59 offen lds
  s_nop 0
  s_add_u32 m0, s12, 17408
  s_add_u32 s59, s56, 8192
  buffer_load_dwordx4 v8, s[72:75], s59 offen lds
  s_add_u32 m0, s12, 18432
  s_add_u32 s59, s56, 16384
  buffer_load_dwordx4 v7, s[72:75], s59 offen lds
  s_add_u32 m0, s12, 19456
  s_add_u32 s59, s56, 24576
  buffer_load_dwordx4 v8, s[72:75], s59 offen lds
  s_add_u32 s56, s81, 2
  s_and_b32 s56, s56, 15
  s_lshl_b32 s56, s56, 5
  s_add_u32 m0, s13, 90112
  s_mul_i32 s59, s60, s56
  buffer_load_dwordx4 v2, s[24:27], s59 offen lds
  s_add_u32 m0, s13, 94208
  s_mul_i32 s59, s61, s56
  buffer_load_dwordx4 v3, s[28:31], s59 offen lds
  s_add_u32 m0, s13, 98304
  s_mul_i32 s59, s62, s56
  buffer_load_dwordx4 v4, s[32:35], s59 offen lds
  s_add_u32 m0, s13, 102400
  s_mul_i32 s59, s63, s56
  buffer_load_dwordx4 v5, s[36:39], s59 offen lds
  s_add_u32 m0, s13, 106496
  s_mul_i32 s59, s64, s56
  buffer_load_dwordx4 v6, s[40:43], s59 offen lds
  s_lshl_b32 s57, s48, 13
  s_lshl_b32 s58, s15, 11
  s_add_u32 s57, s57, s58
  buffer_load_dwordx4 v[32:35], v9, s[72:75], s57 offen
  buffer_load_dwordx4 v[36:39], v9, s[72:75], s57 offen offset:1024
  buffer_load_dword v11, v10, s[16:19], 0 offen sc1
  s_cmp_eq_u32 s55, 0
  s_cbranch_scc0 H_NOCS0
  s_nop 0
  v_add_u32 v12, 49152, v12
  ds_read_b64_tr_b16 v[48:49], v12 offset:0
  ds_read_b64_tr_b16 v[50:51], v12 offset:256
  ds_read_b64_tr_b16 v[52:53], v12 offset:2048
  ds_read_b64_tr_b16 v[54:55], v12 offset:2304
  ds_read_b64_tr_b16 v[56:57], v12 offset:8192
  ds_read_b64_tr_b16 v[58:59], v12 offset:8448
  ds_read_b64_tr_b16 v[60:61], v12 offset:10240
  ds_read_b64_tr_b16 v[62:63], v12 offset:10496
  ds_read_b64_tr_b16 v[64:65], v12 offset:16384
  ds_read_b64_tr_b16 v[66:67], v12 offset:16640
  ds_read_b64_tr_b16 v[68:69], v12 offset:18432
  ds_read_b64_tr_b16 v[70:71], v12 offset:18688
  s_waitcnt lgkmcnt(0)
H_NOCS0:
  s_waitcnt vmcnt(12)
  s_barrier
  s_add_u32 s56, s81, 3
  s_and_b32 s56, s56, 15
  s_lshl_b32 s56, s56, 5
  s_add_u32 m0, s13, 110592
  s_mul_i32 s59, s60, s56
  buffer_load_dwordx4 v2, s[24:27], s59 offen lds
  s_add_u32 m0, s13, 114688
  s_mul_i32 s59, s61, s56
  buffer_load_dwordx4 v3, s[28:31], s59 offen lds
  s_add_u32 m0, s13, 118784
  s_mul_i32 s59, s62, s56
  buffer_load_dwordx4 v4, s[32:35], s59 offen lds
  s_add_u32 m0, s13, 122880
  s_mul_i32 s59, s63, s56
  buffer_load_dwordx4 v5, s[36:39], s59 offen lds
  s_add_u32 m0, s13, 126976
  s_mul_i32 s59, s64, s56
  buffer_load_dwordx4 v6, s[40:43], s59 offen lds
  s_cmp_eq_u32 s55, 1
  s_cbranch_scc0 H_NOCS1
  s_nop 0
  v_add_u32 v12, 69632, v12
  ds_read_b64_tr_b16 v[48:49], v12 offset:0
  ds_read_b64_tr_b16 v[50:51], v12 offset:256
  ds_read_b64_tr_b16 v[52:53], v12 offset:2048
  ds_read_b64_tr_b16 v[54:55], v12 offset:2304
  ds_read_b64_tr_b16 v[56:57], v12 offset:8192
  ds_read_b64_tr_b16 v[58:59], v12 offset:8448
  ds_read_b64_tr_b16 v[60:61], v12 offset:10240
  ds_read_b64_tr_b16 v[62:63], v12 offset:10496
  ds_read_b64_tr_b16 v[64:65], v12 offset:16384
  ds_read_b64_tr_b16 v[66:67], v12 offset:16640
  ds_read_b64_tr_b16 v[68:69], v12 offset:18432
  ds_read_b64_tr_b16 v[70:71], v12 offset:18688
  s_waitcnt lgkmcnt(0)
H_NOCS1:
  s_waitcnt vmcnt(8)
  s_barrier
  s_add_u32 s56, s81, 4
  s_and_b32 s56, s56, 15
  s_lshl_b32 s56, s56, 6
  s_add_u32 m0, s12, 32768
  s_add_u32 s59, s56, 0
  buffer_load_dwordx4 v7, s[72:75], s59 offen lds
  s_nop 0
  s_add_u32 m0, s12, 33792
  s_add_u32 s59, s56, 8192
  buffer_load_dwordx4 v8, s[72:75], s59 offen lds
  s_add_u32 m0, s12, 34816
  s_add_u32 s59, s56, 16384
  buffer_load_dwordx4 v7, s[72:75], s59 offen lds
  s_add_u32 m0, s12, 35840
  s_add_u32 s59, s56, 24576
  buffer_load_dwordx4 v8, s[72:75], s59 offen lds
  s_add_u32 s56, s81, 4
  s_and_b32 s56, s56, 15
  s_lshl_b32 s56, s56, 5
  s_add_u32 m0, s13, 131072
  s_mul_i32 s59, s60, s56
  buffer_load_dwordx4 v2, s[24:27], s59 offen lds
  s_add_u32 m0, s13, 135168
  s_mul_i32 s59, s61, s56
  buffer_load_dwordx4 v3, s[28:31], s59 offen lds
  s_add_u32 m0, s13, 139264
  s_mul_i32 s59, s62, s56
  buffer_load_dwordx4 v4, s[32:35], s59 offen lds
  s_add_u32 m0, s13, 143360
  s_mul_i32 s59, s63, s56
  buffer_load_dwordx4 v5, s[36:39], s59 offen lds
  s_add_u32 m0, s13, 147456
  s_mul_i32 s59, s64, s56
  buffer_load_dwordx4 v6, s[40:43], s59 offen lds
  s_add_u32 s56, s81, 5
  s_and_b32 s56, s56, 15
  s_lshl_b32 s56, s56, 5
  s_add_u32 m0, s13, 49152
  s_mul_i32 s59, s60, s56
  buffer_load_dwordx4 v2, s[24:27], s59 offen lds
  s_add_u32 m0, s13, 53248
  s_mul_i32 s59, s61, s56
  buffer_load_dwordx4 v3, s[28:31], s59 offen lds
  s_add_u32 m0, s13, 57344
  s_mul_i32 s59, s62, s56
  buffer_load_dwordx4 v4, s[32:35], s59 offen lds
  s_add_u32 m0, s13, 61440
  s_mul_i32 s59, s63, s56
  buffer_load_dwordx4 v5, s[36:39], s59 offen lds
  s_add_u32 m0, s13, 65536
  s_mul_i32 s59, s64, s56
  buffer_load_dwordx4 v6, s[40:43], s59 offen lds
  s_cmp_eq_u32 s55, 2
  s_cbranch_scc0 H_NOCS2
  v_add_u32 v12, 90112, v12
  ds_read_b64_tr_b16 v[48:49], v12 offset:0
  ds_read_b64_tr_b16 v[50:51], v12 offset:256
  ds_read_b64_tr_b16 v[52:53], v12 offset:2048
  ds_read_b64_tr_b16 v[54:55], v12 offset:2304
  ds_read_b64_tr_b16 v[56:57], v12 offset:8192
  ds_read_b64_tr_b16 v[58:59], v12 offset:8448
  ds_read_b64_tr_b16 v[60:61], v12 offset:10240
  ds_read_b64_tr_b16 v[62:63], v12 offset:10496
  ds_read_b64_tr_b16 v[64:65], v12 offset:16384
  ds_read_b64_tr_b16 v[66:67], v12 offset:16640
  ds_read_b64_tr_b16 v[68:69], v12 offset:18432
  ds_read_b64_tr_b16 v[70:71], v12 offset:18688
  s_waitcnt lgkmcnt(0)
H_NOCS2:
  s_waitcnt vmcnt(14)
  s_barrier
  s_add_u32 s56, s81, 6
  s_and_b32 s56, s56, 15
  s_lshl_b32 s56, s56, 6
  s_add_u32 m0, s12, 0
  s_add_u32 s59, s56, 0
  buffer_load_dwordx4 v7, s[72:75], s59 offen lds
  s_add_u32 m0, s12, 1024
  s_add_u32 s59, s56, 8192
  buffer_load_dwordx4 v8, s[72:75], s59 offen lds
  s_add_u32 m0, s12, 2048
  s_add_u32 s59, s56, 16384
  buffer_load_dwordx4 v7, s[72:75], s59 offen lds
  s_add_u32 m0, s12, 3072
  s_add_u32 s59, s56, 24576
  buffer_load_dwordx4 v8, s[72:75], s59 offen lds
  s_add_u32 s56, s81, 6
  s_and_b32 s56, s56, 15
  s_lshl_b32 s56, s56, 5
  s_add_u32 m0, s13, 69632
  s_mul_i32 s59, s60, s56
  buffer_load_dwordx4 v2, s[24:27], s59 offen lds
  s_add_u32 m0, s13, 73728
  s_mul_i32 s59, s61, s56
  buffer_load_dwordx4 v3, s[28:31], s59 offen lds
  s_add_u32 m0, s13, 77824
  s_mul_i32 s59, s62, s56
  buffer_load_dwordx4 v4, s[32:35], s59 offen lds
  s_add_u32 m0, s13, 81920
  s_mul_i32 s59, s63, s56
  buffer_load_dwordx4 v5, s[36:39], s59 offen lds
  s_add_u32 m0, s13, 86016
  s_mul_i32 s59, s64, s56
  buffer_load_dwordx4 v6, s[40:43], s59 offen lds
  s_cmp_eq_u32 s55, 3
  s_cbranch_scc0 H_NOCS3
  v_add_u32 v12, 110592, v12
  ds_read_b64_tr_b16 v[48:49], v12 offset:0
  ds_read_b64_tr_b16 v[50:51], v12 offset:256
  ds_read_b64_tr_b16 v[52:53], v12 offset:2048
  ds_read_b64_tr_b16 v[54:55], v12 offset:2304
  ds_read_b64_tr_b16 v[56:57], v12 offset:8192
  ds_read_b64_tr_b16 v[58:59], v12 offset:8448
  ds_read_b64_tr_b16 v[60:61], v12 offset:10240
  ds_read_b64_tr_b16 v[62:63], v12 offset:10496
  ds_read_b64_tr_b16 v[64:65], v12 offset:16384
  ds_read_b64_tr_b16 v[66:67], v12 offset:16640
  ds_read_b64_tr_b16 v[68:69], v12 offset:18432
  ds_read_b64_tr_b16 v[70:71], v12 offset:18688
  s_waitcnt lgkmcnt(0)
H_NOCS3:
  s_load_dwordx2 s[4:5], s[0:1], 48
  s_load_dwordx2 s[8:9], s[0:1], 16
  s_waitcnt vmcnt(14)
  s_barrier
  s_add_u32 s56, s81, 7
  s_and_b32 s56, s56, 15
  s_lshl_b32 s56, s56, 5
  s_add_u32 m0, s13, 90112
  s_mul_i32 s59, s60, s56
  buffer_load_dwordx4 v2, s[24:27], s59 offen lds
  s_add_u32 m0, s13, 94208
  s_mul_i32 s59, s61, s56
  buffer_load_dwordx4 v3, s[28:31], s59 offen lds
  s_add_u32 m0, s13, 98304
  s_mul_i32 s59, s62, s56
  buffer_load_dwordx4 v4, s[32:35], s59 offen lds
  s_add_u32 m0, s13, 102400
  s_mul_i32 s59, s63, s56
  buffer_load_dwordx4 v5, s[36:39], s59 offen lds
  s_add_u32 m0, s13, 106496
  s_mul_i32 s59, s64, s56
  buffer_load_dwordx4 v6, s[40:43], s59 offen lds
  v_lshlrev_b32 v18, 16, v32
  v_and_b32 v19, 0xffff0000, v32
  v_add_f32 v40, v18, v19
  v_mul_f32 v41, v18, v18
  v_fmac_f32 v41, v19, v19
  v_lshlrev_b32 v18, 16, v33
  v_and_b32 v19, 0xffff0000, v33
  v_add_f32 v40, v40, v18
  v_fmac_f32 v41, v18, v18
  v_add_f32 v40, v40, v19
  v_fmac_f32 v41, v19, v19
  v_lshlrev_b32_e64 v18, 16, v34
  v_and_b32 v19, 0xffff0000, v34
  v_add_f32 v40, v40, v18
  v_fmac_f32 v41, v18, v18
  v_add_f32 v40, v40, v19
  v_fmac_f32 v41, v19, v19
  v_lshlrev_b32_e64 v18, 16, v35
  v_and_b32 v19, 0xffff0000, v35
  v_add_f32 v40, v40, v18
  v_fmac_f32 v41, v18, v18
  v_add_f32 v40, v40, v19
  v_fmac_f32 v41, v19, v19
  v_lshlrev_b32_e64 v18, 16, v36
  v_and_b32 v19, 0xffff0000, v36
  v_add_f32 v42, v18, v19
  v_mul_f32 v43, v18, v18
  v_fmac_f32 v43, v19, v19
  v_lshlrev_b32 v18, 16, v37
  v_and_b32 v19, 0xffff0000, v37
  v_add_f32 v42, v42, v18
  v_fmac_f32 v43, v18, v18
  v_add_f32 v42, v42, v19
  v_fmac_f32 v43, v19, v19
  v_lshlrev_b32_e64 v18, 16, v38
  v_and_b32 v19, 0xffff0000, v38
  v_add_f32 v42, v42, v18
  v_fmac_f32 v43, v18, v18
  v_add_f32 v42, v42, v19
  v_fmac_f32 v43, v19, v19
  v_lshlrev_b32_e64 v18, 16, v39
  v_and_b32 v19, 0xffff0000, v39
  v_add_f32 v42, v42, v18
  v_fmac_f32 v43, v18, v18
  v_add_f32 v42, v42, v19
  v_fmac_f32 v43, v19, v19
  v_lshlrev_b32_e64 v18, 16, v48
  v_and_b32 v19, 0xffff0000, v48
  v_add_f32 v44, v18, v19
  v_lshlrev_b32 v18, 16, v49
  v_and_b32 v19, 0xffff0000, v49
  v_add_f32 v44, v44, v18
  v_add_f32 v44, v44, v19
  v_lshlrev_b32_e64 v18, 16, v50
  v_and_b32 v19, 0xffff0000, v50
  v_add_f32 v44, v44, v18
  v_add_f32 v44, v44, v19
  v_lshlrev_b32_e64 v18, 16, v51
  v_and_b32 v19, 0xffff0000, v51
  v_add_f32 v44, v44, v18
  v_add_f32 v44, v44, v19
  v_lshlrev_b32_e64 v18, 16, v52
  v_and_b32 v19, 0xffff0000, v52
  v_add_f32 v44, v44, v18
  v_add_f32 v44, v44, v19
  v_lshlrev_b32_e64 v18, 16, v53
  v_and_b32 v19, 0xffff0000, v53
  v_add_f32 v44, v44, v18
  v_add_f32 v44, v44, v19
  v_lshlrev_b32_e64 v18, 16, v54
  v_and_b32 v19, 0xffff0000, v54
  v_add_f32 v44, v44, v18
  v_add_f32 v44, v44, v19
  v_lshlrev_b32_e64 v18, 16, v55
  v_and_b32 v19, 0xffff0000, v55
  v_add_f32 v44, v44, v18
  v_add_f32 v44, v44, v19
  s_cmp_lg_u32 s15, 0
  s_cbranch_scc1 H_NOWARM
  s_mul_i32 s57, s2, 7168
  s_lshl_b32 s58, s2, 11
  v_lshlrev_b32_e64 v20, 7, v1
  s_waitcnt lgkmcnt(0)
  s_add_u32 s6, s57, 7168
  s_mov_b32 s7, 0x20000
  s_add_u32 s10, s58, 2048
  s_mov_b32 s11, 0x20000
  buffer_load_dword v21, v20, s[4:7], s57 offen
  buffer_load_dword v22, v20, s[8:11], s58 offen
H_NOWARM:
  s_waitcnt vmcnt(14)
  s_barrier
  s_add_u32 s56, s81, 8
  s_and_b32 s56, s56, 15
  s_lshl_b32 s56, s56, 6
  s_add_u32 m0, s12, 16384
  s_add_u32 s59, s56, 0
  buffer_load_dwordx4 v7, s[72:75], s59 offen lds
  s_add_u32 m0, s12, 17408
  s_add_u32 s59, s56, 8192
  buffer_load_dwordx4 v8, s[72:75], s59 offen lds
  s_add_u32 m0, s12, 18432
  s_add_u32 s59, s56, 16384
  buffer_load_dwordx4 v7, s[72:75], s59 offen lds
  s_add_u32 m0, s12, 19456
  s_add_u32 s59, s56, 24576
  buffer_load_dwordx4 v8, s[72:75], s59 offen lds
  s_add_u32 s56, s81, 8
  s_and_b32 s56, s56, 15
  s_lshl_b32 s56, s56, 5
  s_add_u32 m0, s13, 110592
  s_mul_i32 s59, s60, s56
  buffer_load_dwordx4 v2, s[24:27], s59 offen lds
  s_add_u32 m0, s13, 114688
  s_mul_i32 s59, s61, s56
  buffer_load_dwordx4 v3, s[28:31], s59 offen lds
  s_add_u32 m0, s13, 118784
  s_mul_i32 s59, s62, s56
  buffer_load_dwordx4 v4, s[32:35], s59 offen lds
  s_add_u32 m0, s13, 122880
  s_mul_i32 s59, s63, s56
  buffer_load_dwordx4 v5, s[36:39], s59 offen lds
  s_add_u32 m0, s13, 126976
  s_mul_i32 s59, s64, s56
  buffer_load_dwordx4 v6, s[40:43], s59 offen lds
  v_lshlrev_b32_e64 v18, 16, v56
  v_and_b32 v19, 0xffff0000, v56
  v_add_f32 v45, v18, v19
  v_lshlrev_b32 v18, 16, v57
  v_and_b32 v19, 0xffff0000, v57
  v_add_f32 v45, v45, v18
  v_add_f32 v45, v45, v19
  v_lshlrev_b32_e64 v18, 16, v58
  v_and_b32 v19, 0xffff0000, v58
  v_add_f32 v45, v45, v18
  v_add_f32 v45, v45, v19
  v_lshlrev_b32_e64 v18, 16, v59
  v_and_b32 v19, 0xffff0000, v59
  v_add_f32 v45, v45, v18
  v_add_f32 v45, v45, v19
  v_lshlrev_b32_e64 v18, 16, v60
  v_and_b32 v19, 0xffff0000, v60
  v_add_f32 v45, v45, v18
  v_add_f32 v45, v45, v19
  v_lshlrev_b32_e64 v18, 16, v61
  v_and_b32 v19, 0xffff0000, v61
  v_add_f32 v45, v45, v18
  v_add_f32 v45, v45, v19
  v_lshlrev_b32_e64 v18, 16, v62
  v_and_b32 v19, 0xffff0000, v62
  v_add_f32 v45, v45, v18
  v_add_f32 v45, v45, v19
  v_lshlrev_b32_e64 v18, 16, v63
  v_and_b32 v19, 0xffff0000, v63
  v_add_f32 v45, v45, v18
  v_add_f32_e64 v45, v45, v19
  s_waitcnt vmcnt(14)
  s_barrier
  s_add_u32 s56, s81, 9
  s_and_b32 s56, s56, 15
  s_lshl_b32 s56, s56, 5
  s_add_u32 m0, s13, 131072
  s_mul_i32 s59, s60, s56
  buffer_load_dwordx4 v2, s[24:27], s59 offen lds
  s_add_u32 m0, s13, 135168
  s_mul_i32 s59, s61, s56
  buffer_load_dwordx4 v3, s[28:31], s59 offen lds
  s_add_u32 m0, s13, 139264
  s_mul_i32 s59, s62, s56
  buffer_load_dwordx4 v4, s[32:35], s59 offen lds
  s_add_u32 m0, s13, 143360
  s_mul_i32 s59, s63, s56
  buffer_load_dwordx4 v5, s[36:39], s59 offen lds
  s_add_u32 m0, s13, 147456
  s_mul_i32 s59, s64, s56
  buffer_load_dwordx4 v6, s[40:43], s59 offen lds
  v_lshlrev_b32 v18, 16, v64
  v_and_b32 v19, 0xffff0000, v64
  v_add_f32 v46, v18, v19
  v_lshlrev_b32 v18, 16, v65
  v_and_b32 v19, 0xffff0000, v65
  v_add_f32 v46, v46, v18
  v_add_f32 v46, v46, v19
  v_lshlrev_b32_e64 v18, 16, v66
  v_and_b32 v19, 0xffff0000, v66
  v_add_f32 v46, v46, v18
  v_add_f32 v46, v46, v19
  v_lshlrev_b32_e64 v18, 16, v67
  v_and_b32 v19, 0xffff0000, v67
  v_add_f32 v46, v46, v18
  v_add_f32 v46, v46, v19
  v_lshlrev_b32_e64 v18, 16, v68
  v_and_b32 v19, 0xffff0000, v68
  v_add_f32 v46, v46, v18
  v_add_f32 v46, v46, v19
  v_lshlrev_b32_e64 v18, 16, v69
  v_and_b32 v19, 0xffff0000, v69
  v_add_f32 v46, v46, v18
  v_add_f32 v46, v46, v19
  v_lshlrev_b32_e64 v18, 16, v70
  v_and_b32 v19, 0xffff0000, v70
  v_add_f32 v46, v46, v18
  v_add_f32 v46, v46, v19
  v_lshlrev_b32_e64 v18, 16, v71
  v_and_b32 v19, 0xffff0000, v71
  v_add_f32 v46, v46, v18
  v_add_f32 v46, v46, v19
  v_mov_b32 v72, v44
  v_mov_b32 v74, v45
  v_mov_b32 v76, v46
  s_nop 1
  v_permlane32_swap_b32 v72, v44
  v_permlane32_swap_b32 v74, v45
  v_permlane32_swap_b32 v76, v46
  s_nop 1
  v_add_f32 v72, v72, v44
  v_add_f32 v74, v74, v45
  v_add_f32_e64 v76, v76, v46
  v_add_f32_dpp v40, v40, v40 quad_perm:[1,0,3,2] row_mask:0xf bank_mask:0xf
  v_add_f32_dpp v41, v41, v41 quad_perm:[1,0,3,2] row_mask:0xf bank_mask:0xf
  v_add_f32_dpp v42, v42, v42 quad_perm:[1,0,3,2] row_mask:0xf bank_mask:0xf
  v_add_f32_dpp v43, v43, v43 quad_perm:[1,0,3,2] row_mask:0xf bank_mask:0xf
  v_add_f32_dpp v40, v40, v40 quad_perm:[2,3,0,1] row_mask:0xf bank_mask:0xf
  v_add_f32_dpp v41, v41, v41 quad_perm:[2,3,0,1] row_mask:0xf bank_mask:0xf
  v_add_f32_dpp v42, v42, v42 quad_perm:[2,3,0,1] row_mask:0xf bank_mask:0xf
  v_add_f32_dpp v43, v43, v43 quad_perm:[2,3,0,1] row_mask:0xf bank_mask:0xf
  v_add_f32_dpp v40, v40, v40 row_half_mirror row_mask:0xf bank_mask:0xf
  v_add_f32_dpp v41, v41, v41 row_half_mirror row_mask:0xf bank_mask:0xf
  v_add_f32_dpp v42, v42, v42 row_half_mirror row_mask:0xf bank_mask:0xf
  v_add_f32_dpp v43, v43, v43 row_half_mirror row_mask:0xf bank_mask:0xf
  v_add_f32_dpp v40, v40, v40 row_mirror row_mask:0xf bank_mask:0xf
  v_add_f32_dpp v41, v41, v41 row_mirror row_mask:0xf bank_mask:0xf
  v_add_f32_dpp v42, v42, v42 row_mirror row_mask:0xf bank_mask:0xf
  v_add_f32_dpp v43, v43, v43 row_mirror row_mask:0xf bank_mask:0xf
  v_add_f32_dpp v40, v40, v40 row_bcast:15 row_mask:0xa bank_mask:0xf
  v_add_f32_dpp v41, v41, v41 row_bcast:15 row_mask:0xa bank_mask:0xf
  v_add_f32_dpp v42, v42, v42 row_bcast:15 row_mask:0xa bank_mask:0xf
  v_add_f32_dpp v43, v43, v43 row_bcast:15 row_mask:0xa bank_mask:0xf
  v_add_f32_dpp v40, v40, v40 row_bcast:31 row_mask:0xc bank_mask:0xf
  v_add_f32_dpp v41, v41, v41 row_bcast:31 row_mask:0xc bank_mask:0xf
  v_add_f32_dpp v42, v42, v42 row_bcast:31 row_mask:0xc bank_mask:0xf
  v_add_f32_dpp v43, v43, v43 row_bcast:31 row_mask:0xc bank_mask:0xf
  v_readfirstlane_b32 s80, v11
  s_mov_b32 s57, 0
  s_cmp_eq_u32 s80, 0
  s_cbranch_scc0 H_GOTN
H_POLLN:
  buffer_load_dword v11, v10, s[16:19], 0 offen sc1
  s_add_u32 s57, s57, 1
  s_waitcnt vmcnt(0)
  v_readfirstlane_b32 s80, v11
  s_cmp_gt_u32 s57, 20000
  s_cbranch_scc1 H_GOTN
  s_cmp_eq_u32 s80, 0
  s_cbranch_scc1 H_POLLN
H_GOTN:
  s_lshl_b32 s57, s48, 4
  s_add_u32 s57, s57, s47
  s_mul_i32 s57, s57, 2560
  s_lshl_b32 s58, s15, 8
  s_add_u32 s57, s57, s58
  s_add_u32 s57, s57, 16842752
  v_lshlrev_b32 v16, 3, v1
  v_mov_b32 v73, s80
  v_mov_b32 v75, s80
  v_mov_b32_e64 v77, s80
  s_mov_b32 exec_hi, 0
  buffer_store_dwordx2 v[72:73], v16, s[20:23], s57 offen sc1
  buffer_store_dwordx2 v[74:75], v16, s[20:23], s57 offen offset:1024 sc1
  s_cmp_ge_u32 s15, 2
  s_cbranch_scc1 H_NO3
  buffer_store_dwordx2 v[76:77], v16, s[20:23], s57 offen offset:2048 sc1
H_NO3:
  s_mov_b32 exec_lo, 0
  s_mov_b32 exec_hi, 0x80000000
  s_lshl_b32 s57, s69, 6
  s_lshl_b32 s58, s48, 7
  s_add_u32 s57, s57, s58
  s_lshl_b32 s58, s15, 5
  s_add_u32 s57, s57, s58
  s_add_u32 s57, s57, 16777216
  v_mov_b32 v48, v40
  v_mov_b32 v49, v41
  v_mov_b32 v50, s80
  v_mov_b32 v51, s80
  v_mov_b32 v52, v42
  v_mov_b32 v53, v43
  v_mov_b32 v54, s80
  v_mov_b32 v55, s80
  buffer_store_dwordx4 v[48:51], v10, s[20:23], s57 offen sc1
  buffer_store_dwordx4 v[52:55], v10, s[20:23], s57 offen offset:16 sc1
  s_mov_b64 exec, -1
  s_waitcnt vmcnt(14)
  s_barrier
  s_add_u32 s56, s81, 10
  s_and_b32 s56, s56, 15
  s_lshl_b32 s56, s56, 6
  s_add_u32 m0, s12, 32768
  s_add_u32 s59, s56, 0
  buffer_load_dwordx4 v7, s[72:75], s59 offen lds
  s_nop 0
  s_add_u32 m0, s12, 33792
  s_add_u32 s59, s56, 8192
  buffer_load_dwordx4 v8, s[72:75], s59 offen lds
  s_add_u32 m0, s12, 34816
  s_add_u32 s59, s56, 16384
  buffer_load_dwordx4 v7, s[72:75], s59 offen lds
  s_add_u32 m0, s12, 35840
  s_add_u32 s59, s56, 24576
  buffer_load_dwordx4 v8, s[72:75], s59 offen lds
  s_add_u32 s56, s81, 10
  s_and_b32 s56, s56, 15
  s_lshl_b32 s56, s56, 5
  s_add_u32 m0, s13, 49152
  s_mul_i32 s59, s60, s56
  buffer_load_dwordx4 v2, s[24:27], s59 offen lds
  s_add_u32 m0, s13, 53248
  s_mul_i32 s59, s61, s56
  buffer_load_dwordx4 v3, s[28:31], s59 offen lds
  s_add_u32 m0, s13, 57344
  s_mul_i32 s59, s62, s56
  buffer_load_dwordx4 v4, s[32:35], s59 offen lds
  s_add_u32 m0, s13, 61440
  s_mul_i32 s59, s63, s56
  buffer_load_dwordx4 v5, s[36:39], s59 offen lds
  s_add_u32 m0, s13, 65536
  s_mul_i32 s59, s64, s56
  buffer_load_dwordx4 v6, s[40:43], s59 offen lds
  s_waitcnt vmcnt(14)
  s_barrier
  s_add_u32 s56, s81, 11
  s_and_b32 s56, s56, 15
  s_lshl_b32 s56, s56, 5
  s_add_u32 m0, s13, 69632
  s_mul_i32 s59, s60, s56
  buffer_load_dwordx4 v2, s[24:27], s59 offen lds
  s_add_u32 m0, s13, 73728
  s_mul_i32 s59, s61, s56
  buffer_load_dwordx4 v3, s[28:31], s59 offen lds
  s_add_u32 m0, s13, 77824
  s_mul_i32 s59, s62, s56
  buffer_load_dwordx4 v4, s[32:35], s59 offen lds
  s_add_u32 m0, s13, 81920
  s_mul_i32 s59, s63, s56
  buffer_load_dwordx4 v5, s[36:39], s59 offen lds
  s_add_u32 m0, s13, 86016
  s_mul_i32 s59, s64, s56
  buffer_load_dwordx4 v6, s[40:43], s59 offen lds
  s_mul_i32 s66, s48, 40960
  s_add_u32 s66, s66, 16842752
  v_and_b32 v18, 31, v1
  v_lshlrev_b32 v18, 4, v18
  v_lshrrev_b32_e64 v16, 5, v1
  v_mul_u32_u24 v16, 2560, v16
  s_lshl_b32 s58, s15, 9
  v_add3_u32 v16, v16, v18, s58
  v_and_b32 v17, 7, v1
  v_lshlrev_b32 v17, 4, v17
  v_lshrrev_b32 v19, 3, v1
  v_mul_u32_u24 v19, 2560, v19
  s_lshl_b32 s58, s15, 7
  s_add_u32 s58, s58, 2048
  v_add3_u32 v17, v17, v19, s58
  s_lshl_b32 s67, s69, 6
  s_lshl_b32 s59, s15, 9
  s_add_u32 s67, s67, s59
  s_add_u32 s67, s67, 16777216
  s_waitcnt vmcnt(14)
  s_barrier
  s_add_u32 s56, s81, 12
  s_and_b32 s56, s56, 15
  s_lshl_b32 s56, s56, 6
  s_add_u32 m0, s12, 0
  s_add_u32 s59, s56, 0
  buffer_load_dwordx4 v7, s[72:75], s59 offen lds
  s_nop 0
  s_add_u32 m0, s12, 1024
  s_add_u32 s59, s56, 8192
  buffer_load_dwordx4 v8, s[72:75], s59 offen lds
  s_add_u32 m0, s12, 2048
  s_add_u32 s59, s56, 16384
  buffer_load_dwordx4 v7, s[72:75], s59 offen lds
  s_add_u32 m0, s12, 3072
  s_add_u32 s59, s56, 24576
  buffer_load_dwordx4 v8, s[72:75], s59 offen lds
  s_add_u32 s56, s81, 12
  s_and_b32 s56, s56, 15
  s_lshl_b32 s56, s56, 5
  s_add_u32 m0, s13, 90112
  s_mul_i32 s59, s60, s56
  buffer_load_dwordx4 v2, s[24:27], s59 offen lds
  s_add_u32 m0, s13, 94208
  s_mul_i32 s59, s61, s56
  buffer_load_dwordx4 v3, s[28:31], s59 offen lds
  s_add_u32 m0, s13, 98304
  s_mul_i32 s59, s62, s56
  buffer_load_dwordx4 v4, s[32:35], s59 offen lds
  s_add_u32 m0, s13, 102400
  s_mul_i32 s59, s63, s56
  buffer_load_dwordx4 v5, s[36:39], s59 offen lds
  s_add_u32 m0, s13, 106496
  s_mul_i32 s59, s64, s56
  buffer_load_dwordx4 v6, s[40:43], s59 offen lds
  s_waitcnt vmcnt(14)
  s_barrier
  s_add_u32 s56, s81, 13
  s_and_b32 s56, s56, 15
  s_lshl_b32 s56, s56, 5
  s_add_u32 m0, s13, 110592
  s_mul_i32 s59, s60, s56
  buffer_load_dwordx4 v2, s[24:27], s59 offen lds
  s_add_u32 m0, s13, 114688
  s_mul_i32 s59, s61, s56
  buffer_load_dwordx4 v3, s[28:31], s59 offen lds
  s_add_u32 m0, s13, 118784
  s_mul_i32 s59, s62, s56
  buffer_load_dwordx4 v4, s[32:35], s59 offen lds
  s_add_u32 m0, s13, 122880
  s_mul_i32 s59, s63, s56
  buffer_load_dwordx4 v5, s[36:39], s59 offen lds
  s_add_u32 m0, s13, 126976
  s_mul_i32 s59, s64, s56
  buffer_load_dwordx4 v6, s[40:43], s59 offen lds
  s_add_u32 s59, s66, 0
  buffer_load_dwordx4 v[64:67], v16, s[20:23], s59 offen sc1
  s_nop 0
  s_add_u32 s59, s66, 5120
  buffer_load_dwordx4 v[68:71], v16, s[20:23], s59 offen sc1
  s_add_u32 s59, s66, 10240
  buffer_load_dwordx4 v[72:75], v16, s[20:23], s59 offen sc1
  s_add_u32 s59, s66, 15360
  buffer_load_dwordx4 v[76:79], v16, s[20:23], s59 offen sc1
  s_add_u32 s59, s66, 20480
  buffer_load_dwordx4 v[80:83], v16, s[20:23], s59 offen sc1
  s_add_u32 s59, s66, 25600
  buffer_load_dwordx4 v[84:87], v16, s[20:23], s59 offen sc1
  s_waitcnt vmcnt(20)
  s_barrier
  s_add_u32 s56, s81, 14
  s_and_b32 s56, s56, 15
  s_lshl_b32 s56, s56, 6
  s_add_u32 m0, s12, 16384
  s_add_u32 s59, s56, 0
  buffer_load_dwordx4 v7, s[72:75], s59 offen lds
  s_add_u32 m0, s12, 17408
  s_add_u32 s59, s56, 8192
  buffer_load_dwordx4 v8, s[72:75], s59 offen lds
  s_add_u32 m0, s12, 18432
  s_add_u32 s59, s56, 16384
  buffer_load_dwordx4 v7, s[72:75], s59 offen lds
  s_add_u32 m0, s12, 19456
  s_add_u32 s59, s56, 24576
  buffer_load_dwordx4 v8, s[72:75], s59 offen lds
  s_add_u32 s56, s81, 14
  s_and_b32 s56, s56, 15
  s_lshl_b32 s56, s56, 5
  s_add_u32 m0, s13, 131072
  s_mul_i32 s59, s60, s56
  buffer_load_dwordx4 v2, s[24:27], s59 offen lds
  s_add_u32 m0, s13, 135168
  s_mul_i32 s59, s61, s56
  buffer_load_dwordx4 v3, s[28:31], s59 offen lds
  s_add_u32 m0, s13, 139264
  s_mul_i32 s59, s62, s56
  buffer_load_dwordx4 v4, s[32:35], s59 offen lds
  s_add_u32 m0, s13, 143360
  s_mul_i32 s59, s63, s56
  buffer_load_dwordx4 v5, s[36:39], s59 offen lds
  s_add_u32 m0, s13, 147456
  s_mul_i32 s59, s64, s56
  buffer_load_dwordx4 v6, s[40:43], s59 offen lds
  s_add_u32 s59, s66, 30720
  buffer_load_dwordx4 v[88:91], v16, s[20:23], s59 offen sc1
  s_add_u32 s59, s66, 35840
  buffer_load_dwordx4 v[92:95], v16, s[20:23], s59 offen sc1
  s_add_u32 s59, s66, 0
  buffer_load_dwordx4 v[96:99], v17, s[20:23], s59 offen sc1
  s_nop 0
  s_add_u32 s59, s66, 20480
  buffer_load_dwordx4 v[100:103], v17, s[20:23], s59 offen sc1
  buffer_load_dwordx4 v[104:107], v18, s[20:23], s67 offen sc1
  s_waitcnt vmcnt(25)
  s_barrier
  s_add_u32 s56, s81, 15
  s_and_b32 s56, s56, 15
  s_lshl_b32 s56, s56, 5
  s_add_u32 m0, s13, 49152
  s_mul_i32 s59, s60, s56
  buffer_load_dwordx4 v2, s[24:27], s59 offen lds
  s_add_u32 m0, s13, 53248
  s_mul_i32 s59, s61, s56
  buffer_load_dwordx4 v3, s[28:31], s59 offen lds
  s_add_u32 m0, s13, 57344
  s_mul_i32 s59, s62, s56
  buffer_load_dwordx4 v4, s[32:35], s59 offen lds
  s_add_u32 m0, s13, 61440
  s_mul_i32 s59, s63, s56
  buffer_load_dwordx4 v5, s[36:39], s59 offen lds
  s_add_u32 m0, s13, 65536
  s_mul_i32 s59, s64, s56
  buffer_load_dwordx4 v6, s[40:43], s59 offen lds
  s_load_dwordx2 s[24:25], s[0:1], 48
  s_load_dwordx2 s[28:29], s[0:1], 16
  v_bfe_u32 v6, v1, 2, 3
  v_lshlrev_b32 v6, 10, v6
  v_lshrrev_b32 v7, 5, v1
  v_lshlrev_b32 v7, 6, v7
  v_add_u32 v6, v6, v7
  v_and_b32 v7, 3, v1
  v_lshlrev_b32 v7, 4, v7
  v_add_u32 v2, v6, v7
  s_lshl_b32 s43, s15, 11
  s_lshr_b32 s58, s2, 5
  s_lshl_b32 s40, s58, 7
  s_lshl_b32 s42, s15, 17
  s_add_u32 s42, s42, s40
  s_mul_i32 s57, s15, 24
  s_mul_i32 s59, s58, 11
  s_lshr_b32 s59, s59, 5
  s_mul_i32 s59, s59, 3
  s_sub_u32 s59, s58, s59
  s_lshl_b32 s60, s59, 3
  s_add_u32 s60, s60, s57
  s_add_u32 s60, s60, 4
  s_add_u32 s59, s59, 1
  s_cmp_eq_u32 s59, 3
  s_cselect_b32 s59, 0, s59
  s_lshl_b32 s61, s59, 3
  s_add_u32 s61, s61, s57
  s_add_u32 s61, s61, 4
  s_add_u32 s59, s59, 1
  s_cmp_eq_u32 s59, 3
  s_cselect_b32 s59, 0, s59
  s_lshl_b32 s62, s59, 3
  s_add_u32 s62, s62, s57
  s_add_u32 s62, s62, 4
  s_add_u32 s59, s59, 1
  s_cmp_eq_u32 s59, 3
  s_cselect_b32 s59, 0, s59
  s_lshl_b32 s41, s15, 2
  s_add_u32 s41, s41, 96
  s_add_u32 s59, s58, 0
  s_and_b32 s59, s59, 3
  s_lshl_b32 s44, s59, 3
  s_add_u32 s44, s44, s57
  s_cmp_eq_u32 s59, 3
  s_cselect_b32 s76, s41, s44
  s_add_u32 s59, s58, 1
  s_and_b32 s59, s59, 3
  s_lshl_b32 s44, s59, 3
  s_add_u32 s44, s44, s57
  s_cmp_eq_u32 s59, 3
  s_cselect_b32 s77, s41, s44
  s_add_u32 s59, s58, 2
  s_and_b32 s59, s59, 3
  s_lshl_b32 s44, s59, 3
  s_add_u32 s44, s44, s57
  s_cmp_eq_u32 s59, 3
  s_cselect_b32 s78, s41, s44
  s_add_u32 s59, s58, 3
  s_and_b32 s59, s59, 3
  s_lshl_b32 s44, s59, 3
  s_add_u32 s44, s44, s57
  s_cmp_eq_u32 s59, 3
  s_cselect_b32 s79, s41, s44
  s_waitcnt lgkmcnt(0)
  s_nop 0
  s_mov_b32 s26, 0x1c0000
  s_mov_b32 s27, 0x20000
  s_mov_b32 s30, 0x80000
  s_mov_b32 s31, 0x20000
  s_waitcnt vmcnt(25)
  s_barrier
  s_waitcnt vmcnt(5)
  v_and_b32 v19, v65, v67
  v_or_b32_e64 v20, v65, v67
  v_bitop3_b32 v19, v19, v69, v71 bitop3:0x80
  v_or3_b32 v20, v20, v69, v71
  v_bitop3_b32 v19, v19, v73, v75 bitop3:0x80
  v_or3_b32 v20, v20, v73, v75
  v_bitop3_b32 v19, v19, v77, v79 bitop3:0x80
  v_or3_b32 v20, v20, v77, v79
  v_bitop3_b32 v19, v19, v81, v83 bitop3:0x80
  v_or3_b32 v20, v20, v81, v83
  v_bitop3_b32 v19, v19, v85, v87 bitop3:0x80
  v_or3_b32 v20, v20, v85, v87
  v_bitop3_b32 v19, v19, v89, v91 bitop3:0x80
  v_or3_b32 v20, v20, v89, v91
  v_bitop3_b32 v19, v19, v93, v95 bitop3:0x80
  v_or3_b32 v20, v20, v93, v95
  v_bitop3_b32 v19, v19, v97, v99 bitop3:0x80
  v_or3_b32 v20, v20, v97, v99
  v_bitop3_b32 v19, v19, v101, v103 bitop3:0x80
  v_or3_b32 v20, v20, v101, v103
  v_and_b32 v19, v19, v106
  v_or_b32 v20, v20, v106
  v_xor_b32 v19, s80, v19
  v_xor_b32 v20, s80, v20
  v_or_b32_e64 v19, v19, v20
  v_cmp_eq_u32 vcc, 0, v19
  s_nop 0
  s_cmp_eq_u64 vcc, -1
  s_cselect_b32 s70, 1, 0
  s_lshl_b32 s44, s60, 14
  s_add_u32 s44, s44, s40
  s_add_u32 m0, s43, 32768
  s_add_u32 s45, s44, 8192
  buffer_load_dwordx4 v2, s[24:27], s44 offen lds
  s_add_u32 m0, s43, 33792
  s_nop 0
  buffer_load_dwordx4 v2, s[24:27], s45 offen lds
  s_lshl_b32 s44, s60, 14
  s_add_u32 s44, s44, s40
  s_nop 0
  s_add_u32 s44, s44, 16384
  s_add_u32 m0, s43, 40960
  s_add_u32 s45, s44, 8192
  buffer_load_dwordx4 v2, s[24:27], s44 offen lds
  s_add_u32 m0, s43, 41984
  s_nop 0
  buffer_load_dwordx4 v2, s[24:27], s45 offen lds
  s_lshl_b32 s44, s60, 14
  s_add_u32 s44, s44, s40
  s_nop 0
  s_add_u32 s44, s44, 32768
  s_add_u32 m0, s43, 69632
  s_add_u32 s45, s44, 8192
  buffer_load_dwordx4 v2, s[24:27], s44 offen lds
  s_add_u32 m0, s43, 70656
  s_nop 0
  buffer_load_dwordx4 v2, s[24:27], s45 offen lds
  s_lshl_b32 s44, s60, 14
  s_add_u32 s44, s44, s40
  s_nop 0
  s_add_u32 s44, s44, 49152
  s_add_u32 m0, s43, 77824
  s_add_u32 s45, s44, 8192
  buffer_load_dwordx4 v2, s[24:27], s44 offen lds
  s_add_u32 m0, s43, 78848
  s_nop 0
  buffer_load_dwordx4 v2, s[24:27], s45 offen lds
  s_barrier
  s_lshl_b32 s44, s61, 14
  s_add_u32 s44, s44, s40
  s_add_u32 m0, s43, 86016
  s_add_u32 s45, s44, 8192
  buffer_load_dwordx4 v2, s[24:27], s44 offen lds
  s_add_u32 m0, s43, 87040
  s_nop 0
  buffer_load_dwordx4 v2, s[24:27], s45 offen lds
  s_lshl_b32 s44, s61, 14
  s_add_u32 s44, s44, s40
  s_nop 0
  s_add_u32 s44, s44, 16384
  s_add_u32 m0, s43, 94208
  s_add_u32 s45, s44, 8192
  buffer_load_dwordx4 v2, s[24:27], s44 offen lds
  s_add_u32 m0, s43, 95232
  s_nop 0
  buffer_load_dwordx4 v2, s[24:27], s45 offen lds
  s_lshl_b32 s44, s61, 14
  s_add_u32 s44, s44, s40
  s_nop 0
  s_add_u32 s44, s44, 32768
  s_add_u32 m0, s43, 102400
  s_add_u32 s45, s44, 8192
  buffer_load_dwordx4 v2, s[24:27], s44 offen lds
  s_add_u32 m0, s43, 103424
  s_nop 0
  buffer_load_dwordx4 v2, s[24:27], s45 offen lds
  s_cmp_eq_u32 s70, 0
  s_cbranch_scc1 H_NOCOLS
  v_add_f32 v64, v64, v68
  v_add_f32 v66, v66, v70
  v_add_f32 v72, v72, v76
  v_add_f32 v74, v74, v78
  v_add_f32 v80, v80, v84
  v_add_f32 v82, v82, v86
  v_add_f32 v88, v88, v92
  v_add_f32 v90, v90, v94
  v_add_f32 v64, v64, v72
  v_add_f32 v66, v66, v74
  v_add_f32 v80, v80, v88
  v_add_f32 v82, v82, v90
  v_add_f32 v64, v64, v80
  v_add_f32 v66, v66, v82
  v_add_f32 v96, v96, v100
  v_add_f32 v98, v98, v102
  v_mov_b32 v65, v64
  v_mov_b32_e64 v67, v66
  v_add_f32_dpp v96, v96, v96 row_ror:8 row_mask:0xf bank_mask:0xf
  v_add_f32_dpp v98, v98, v98 row_ror:8 row_mask:0xf bank_mask:0xf
  v_permlane32_swap_b32 v65, v64
  v_permlane32_swap_b32 v67, v66
  v_mov_b32 v97, v96
  v_mov_b32 v99, v98
  v_add_f32 v64, v64, v65
  v_add_f32 v66, v66, v67
  v_permlane32_swap_b32 v97, v96
  v_permlane32_swap_b32 v99, v98
  s_nop 0
  v_add_f32 v96, v96, v97
  v_add_f32 v98, v98, v99
  v_mov_b32 v97, v96
  v_mov_b32 v99, v98
  s_nop 1
  v_permlane16_swap_b32 v97, v96
  v_permlane16_swap_b32 v99, v98
  s_nop 0
  v_add_f32 v96, v96, v97
  v_add_f32_e64 v98, v98, v99
  v_cvt_pk_bf16_f32 v65, v64, v64
  v_and_b32 v65, 0xffff0000, v65
  v_sub_f32_e64 v64, v64, v65
  v_cvt_pk_bf16_f32 v68, v65, v64
  v_cvt_pk_bf16_f32 v67, v66, v66
  v_and_b32 v67, 0xffff0000, v67
  v_sub_f32_e64 v66, v66, v67
  v_cvt_pk_bf16_f32 v69, v67, v66
  v_cvt_pk_bf16_f32 v97, v96, v96
  v_and_b32 v97, 0xffff0000, v97
  v_sub_f32_e64 v96, v96, v97
  v_cvt_pk_bf16_f32 v70, v97, v96
  v_cvt_pk_bf16_f32 v99, v98, v98
  v_and_b32 v99, 0xffff0000, v99
  v_sub_f32_e64 v98, v98, v99
  v_cvt_pk_bf16_f32 v71, v99, v98
  v_lshrrev_b32 v16, 1, v18
  s_lshl_b32 s58, s15, 8
  s_add_u32 s58, s58, 155648
  v_add_u32_e64 v16, s58, v16
  ds_write_b64 v16, v[68:69]
  v_and_b32 v17, 7, v1
  v_lshlrev_b32_e64 v17, 3, v17
  s_lshl_b32 s58, s15, 6
  s_add_u32 s58, s58, 156672
  v_add_u32_e64 v17, s58, v17
  ds_write_b64 v17, v[70:71]
H_NOCOLS:
  s_waitcnt vmcnt(14)
  s_barrier
  s_lshl_b32 s44, s61, 14
  s_add_u32 s44, s44, s40
  s_add_u32 s44, s44, 49152
  s_add_u32 m0, s43, 110592
  s_add_u32 s45, s44, 8192
  buffer_load_dwordx4 v2, s[24:27], s44 offen lds
  s_add_u32 m0, s43, 111616
  s_nop 0
  buffer_load_dwordx4 v2, s[24:27], s45 offen lds
  s_lshl_b32 s44, s62, 14
  s_add_u32 s44, s44, s40
  s_nop 0
  s_add_u32 m0, s43, 118784
  s_add_u32 s45, s44, 8192
  buffer_load_dwordx4 v2, s[24:27], s44 offen lds
  s_add_u32 m0, s43, 119808
  s_nop 0
  buffer_load_dwordx4 v2, s[24:27], s45 offen lds
  s_lshl_b32 s44, s62, 14
  s_add_u32 s44, s44, s40
  s_add_u32 s44, s44, 16384
  s_add_u32 m0, s43, 0
  s_add_u32 s45, s44, 8192
  buffer_load_dwordx4 v2, s[24:27], s44 offen lds
  s_add_u32 m0, s43, 1024
  s_nop 0
  buffer_load_dwordx4 v2, s[24:27], s45 offen lds
  s_lshl_b32 s44, s62, 14
  s_add_u32 s44, s44, s40
  s_nop 0
  s_add_u32 s44, s44, 32768
  s_add_u32 m0, s43, 8192
  s_add_u32 s45, s44, 8192
  buffer_load_dwordx4 v2, s[24:27], s44 offen lds
  s_add_u32 m0, s43, 9216
  s_nop 0
  buffer_load_dwordx4 v2, s[24:27], s45 offen lds
  s_cmp_eq_u32 s70, 0
  s_cbranch_scc1 H_GSLOW
H_GTOK:
  s_nop 0
  v_mul_f32 v104, 0xbb000000, v104
  v_mul_f32 v105, 0x3b000000, v105
  v_fma_f32 v105, -v104, v104, v105
  v_max_f32_e64 v105, 0, v105
  v_add_f32 v113, 0x3727c5ac, v105
  v_rsq_f32_e64 v110, v113
  v_cvt_pk_bf16_f32 v108, v104, v104
  v_and_b32 v106, 0xffff0000, v108
  v_sub_f32_e64 v106, v104, v106
  v_cvt_pk_bf16_f32 v109, v106, v106
  v_mul_f32 v111, 0xc0135761, v110
  v_mul_f32 v112, v110, v110
  v_mul_f32 v112, v112, v110
  v_mul_f32 v112, 0xbdd2d3e8, v112
  v_mov_b32 v114, s80
  v_lshlrev_b32_e64 v18, 1, v18
  s_lshl_b32 s58, s15, 10
  s_add_u32 s58, s58, 151552
  v_add_u32_e64 v18, s58, v18
  ds_write_b128 v18, v[108:111]
  ds_write_b128 v18, v[112:115] offset:16
  s_waitcnt lgkmcnt(0)
  s_barrier
  s_lshl_b32 s44, s62, 14
  s_add_u32 s44, s44, s40
  s_add_u32 s44, s44, 49152
  s_add_u32 m0, s43, 126976
  s_add_u32 s45, s44, 8192
  buffer_load_dwordx4 v2, s[24:27], s44 offen lds
  s_add_u32 m0, s43, 128000
  s_nop 0
  buffer_load_dwordx4 v2, s[24:27], s45 offen lds
  s_lshl_b32 s44, s76, 14
  s_add_u32 s44, s44, s40
  s_nop 0
  s_add_u32 m0, s43, 135168
  s_add_u32 s45, s44, 8192
  buffer_load_dwordx4 v2, s[24:27], s44 offen lds
  s_add_u32 m0, s43, 136192
  s_nop 0
  buffer_load_dwordx4 v2, s[24:27], s45 offen lds
  s_lshl_b32 s44, s76, 14
  s_add_u32 s44, s44, s40
  s_nop 0
  s_add_u32 s44, s44, 16384
  s_add_u32 m0, s43, 143360
  s_add_u32 s45, s44, 8192
  buffer_load_dwordx4 v2, s[24:27], s44 offen lds
  s_add_u32 m0, s43, 144384
  s_nop 0
  buffer_load_dwordx4 v2, s[24:27], s45 offen lds
  s_and_b32 s57, s2, 7
  s_lshr_b32 s58, s2, 3
  s_and_b32 s58, s58, 3
  s_lshl_b32 s50, s58, 3
  s_add_u32 s50, s50, s57
  s_lshr_b32 s47, s2, 5
  s_lshl_b32 s51, s47, 2
  s_add_u32 s51, s51, s15
  v_and_b32 v9, 31, v1
  v_lshlrev_b32 v2, 5, v9
  v_lshrrev_b32 v10, 5, v1
  v_lshlrev_b32 v11, 4, v10
  v_add_u32 v2, v2, v11
  v_lshlrev_b32 v3, 4, v1
  s_lshl_b32 s49, s47, 2
  s_lshl_b32 s57, s15, 1
  s_add_u32 s49, s49, s57
  s_sub_u32 s49, s49, 4
  v_and_b32 v9, 1, v1
  v_add_u32 v9, s49, v9
  v_max_i32 v9, 0, v9
  v_lshlrev_b32_e64 v9, 8, v9
  v_bfe_u32 v10, v1, 1, 1
  v_lshlrev_b32_e64 v10, 6, v10
  v_add3_u32 v9, v9, v10, 64
  s_lshl_b32 s57, s51, 8
  v_mov_b32_e64 v10, s57
  v_cmp_gt_u32 vcc, 4, v1
  s_lshr_b32 s57, s50, 1
  s_lshl_b32 s57, s57, 7
  s_add_u32 s57, s57, 18350080
  v_cndmask_b32 v9, v10, v9, vcc
  v_lshlrev_b32 v9, 5, v9
  v_add_u32_e64 v252, s57, v9
  s_barrier
  s_lshl_b32 s57, s15, 11
  s_add_u32 s57, s57, 49152
  v_add_u32 v4, s57, v2
  v_and_b32 v9, 31, v1
  v_lshrrev_b32 v10, 5, v1
  v_lshlrev_b32 v11, 2, v10
  v_sub_u32_e64 v9, v9, v11
  v_mov_b32 v11, 0xf149f2ca
  v_mov_b32 v124, 0x3f803f80
  v_mov_b32 v125, 0x3f803f80
  v_mov_b32 v126, 0x3f803f80
  v_mov_b32 v127, 0x3f803f80
  v_add_u32 v11, 65536, v3
  ds_write_b128 v11, v[124:127]
  v_mov_b32 v11, 0xf149f2ca
  v_cmp_le_i32 s[60:61], 0, v9
  v_cmp_le_i32 s[62:63], 1, v9
  s_nop 0
  s_nop 0
  v_cndmask_b32 v60, v11, 0, s[60:61]
  v_cndmask_b32 v76, 0, v11, s[60:61]
  v_cmp_le_i32 s[60:61], 2, v9
  s_nop 0
  s_nop 0
  v_cndmask_b32 v61, v11, 0, s[62:63]
  v_cndmask_b32 v77, 0, v11, s[62:63]
  v_cmp_le_i32 s[62:63], 3, v9
  s_nop 0
  s_nop 0
  v_cndmask_b32 v62, v11, 0, s[60:61]
  v_cndmask_b32 v78, 0, v11, s[60:61]
  v_cmp_le_i32 s[60:61], 8, v9
  s_nop 0
  s_nop 0
  v_cndmask_b32 v63, v11, 0, s[62:63]
  v_cndmask_b32 v79, 0, v11, s[62:63]
  v_cmp_le_i32 s[62:63], 9, v9
  s_nop 0
  s_nop 0
  v_cndmask_b32 v64, v11, 0, s[60:61]
  v_cndmask_b32 v80, 0, v11, s[60:61]
  v_cmp_le_i32 s[60:61], 10, v9
  s_nop 0
  s_nop 0
  v_cndmask_b32 v65, v11, 0, s[62:63]
  v_cndmask_b32 v81, 0, v11, s[62:63]
  v_cmp_le_i32 s[62:63], 11, v9
  s_nop 0
  s_nop 0
  v_cndmask_b32 v66, v11, 0, s[60:61]
  v_cndmask_b32 v82, 0, v11, s[60:61]
  v_cmp_le_i32 s[60:61], 16, v9
  s_nop 0
  s_nop 0
  v_cndmask_b32 v67, v11, 0, s[62:63]
  v_cndmask_b32 v83, 0, v11, s[62:63]
  v_cmp_le_i32 s[62:63], 17, v9
  s_nop 0
  s_nop 0
  v_cndmask_b32 v68, v11, 0, s[60:61]
  v_cndmask_b32 v84, 0, v11, s[60:61]
  v_cmp_le_i32 s[60:61], 18, v9
  s_nop 0
  s_nop 0
  v_cndmask_b32 v69, v11, 0, s[62:63]
  v_cndmask_b32 v85, 0, v11, s[62:63]
  v_cmp_le_i32 s[62:63], 19, v9
  s_nop 0
  s_nop 0
  v_cndmask_b32 v70, v11, 0, s[60:61]
  v_cndmask_b32 v86, 0, v11, s[60:61]
  v_cmp_le_i32 s[60:61], 24, v9
  s_nop 0
  s_nop 0
  v_cndmask_b32 v71, v11, 0, s[62:63]
  v_cndmask_b32 v87, 0, v11, s[62:63]
  v_cmp_le_i32 s[62:63], 25, v9
  s_nop 0
  s_nop 0
  v_cndmask_b32 v72, v11, 0, s[60:61]
  v_cndmask_b32 v88, 0, v11, s[60:61]
  v_cmp_le_i32 s[60:61], 26, v9
  s_nop 0
  s_nop 0
  v_cndmask_b32 v73, v11, 0, s[62:63]
  v_cndmask_b32 v89, 0, v11, s[62:63]
  v_cmp_le_i32 s[62:63], 27, v9
  s_nop 0
  s_nop 0
  v_cndmask_b32 v74, v11, 0, s[60:61]
  v_cndmask_b32 v90, 0, v11, s[60:61]
  v_cndmask_b32 v75, v11, 0, s[62:63]
  v_cndmask_b32 v91, 0, v11, s[62:63]
  v_lshlrev_b32_e64 v10, 7, v10
  v_bfe_u32 v9, v1, 2, 2
  v_lshlrev_b32 v9, 5, v9
  v_add_u32 v10, v10, v9
  v_and_b32 v9, 1, v1
  v_lshlrev_b32 v9, 4, v9
  v_add_u32_e64 v10, v10, v9
  v_bfe_u32 v9, v1, 1, 1
  v_lshlrev_b32 v9, 3, v9
  v_add_u32 v10, v10, v9
  v_add_u32_e64 v9, s57, v10
  v_xor_b32 v10, 128, v10
  v_add_u32 v10, 65536, v10
  v_and_b32 v11, 16, v1
  v_cmp_eq_u32 vcc, 0, v11
  v_mov_b32 v11, 1024
  s_nop 0
  v_cndmask_b32 v5, v10, v9, vcc
  v_cndmask_b32 v6, 0, v11, vcc
  s_waitcnt vmcnt(0)
  s_barrier
  s_setprio 3
  s_sleep 48
  buffer_load_dword v253, v252, s[20:23], 0 offen sc1
  s_waitcnt vmcnt(0)
  v_cmp_eq_u32 vcc, s80, v253
  s_mov_b32 s56, 0
  s_cmp_eq_u64 vcc, -1
  s_cbranch_scc1 HQ_OK
HQ_P:
  s_sleep 8
  buffer_load_dword v253, v252, s[20:23], 0 offen sc1
  s_add_u32 s56, s56, 1
  s_waitcnt vmcnt(0)
  v_cmp_eq_u32 vcc, s80, v253
  s_cmp_gt_u32 s56, 20000
  s_cbranch_scc1 HQ_OK
  s_cmp_eq_u64 vcc, -1
  s_cbranch_scc0 HQ_P
HQ_OK:
  s_lshl_b32 s52, s50, 16
  s_lshl_b32 s53, s49, 11
  s_add_i32 s55, s53, 0
  s_max_i32 s55, s55, 0
  s_add_u32 s55, s55, s52
  s_add_u32 s55, s55, 2097152
  buffer_load_dwordx4 v[188:191], v3, s[20:23], s55 offen offset:0 sc1
  buffer_load_dwordx4 v[192:195], v3, s[20:23], s55 offen offset:1024 sc1
  s_add_i32 s55, s53, 2048
  s_max_i32 s55, s55, 0
  s_add_u32 s55, s55, s52
  s_add_u32 s55, s55, 2097152
  buffer_load_dwordx4 v[196:199], v3, s[20:23], s55 offen offset:0 sc1
  buffer_load_dwordx4 v[200:203], v3, s[20:23], s55 offen offset:1024 sc1
  s_add_i32 s55, s53, 0
  s_max_i32 s55, s55, 0
  s_add_u32 s55, s55, s52
  s_nop 0
  s_add_u32 s55, s55, 4194304
  buffer_load_dwordx4 v[204:207], v3, s[20:23], s55 offen offset:0 sc1
  buffer_load_dwordx4 v[208:211], v3, s[20:23], s55 offen offset:1024 sc1
  s_add_i32 s55, s53, 2048
  s_max_i32 s55, s55, 0
  s_add_u32 s55, s55, s52
  s_add_u32 s55, s55, 4194304
  buffer_load_dwordx4 v[212:215], v3, s[20:23], s55 offen offset:0 sc1
  buffer_load_dwordx4 v[216:219], v3, s[20:23], s55 offen offset:1024 sc1
  s_lshl_b32 s53, s51, 11
  s_add_u32 s54, s52, s53
  buffer_load_dwordx4 v[12:15], v3, s[20:23], s54 offen sc1
  buffer_load_dwordx4 v[16:19], v3, s[20:23], s54 offen offset:1024 sc1
  s_lshl_b32 s57, s15, 12
  v_add_u32 v9, s57, v3
  v_add_u32 v10, s57, v2
  s_lshl_b32 s57, s15, 11
  v_add_u32 v11, s57, v3
  s_lshl_b32 s57, s15, 2
  s_add_u32 s57, s57, 66560
  v_mov_b32 v252, s57
  v_mov_b32 v253, s80
  v_mov_b32 v254, 66560
  s_waitcnt vmcnt(9)
  ds_write_b128 v9, v[188:191] offset:16384
  s_waitcnt vmcnt(8)
  ds_write_b128 v9, v[192:195] offset:17408
  s_waitcnt vmcnt(7)
  ds_write_b128 v9, v[196:199] offset:18432
  s_waitcnt vmcnt(6)
  ds_write_b128 v9, v[200:203] offset:19456
  s_waitcnt vmcnt(5)
  ds_write_b128 v10, v[204:207] offset:49152
  s_waitcnt vmcnt(4)
  ds_write_b128 v10, v[208:211] offset:50176
  s_waitcnt vmcnt(3)
  ds_write_b128 v10, v[212:215] offset:51200
  s_waitcnt vmcnt(2)
  ds_write_b128 v10, v[216:219] offset:52224
  s_waitcnt lgkmcnt(0)
  ds_write_b32 v252, v253
  s_mov_b32 s56, 0
H_LW:
  ds_read_b128 v[188:191], v254
  s_add_u32 s56, s56, 1
  s_waitcnt lgkmcnt(0)
  v_xor_b32 v188, s80, v188
  v_xor_b32 v189, s80, v189
  v_xor_b32 v190, s80, v190
  v_xor_b32 v191, s80, v191
  v_or3_b32 v188, v188, v189, v190
  v_or_b32 v188, v188, v191
  v_cmp_eq_u32 vcc, 0, v188
  s_cmp_gt_u32 s56, 1000000
  s_cbranch_scc1 H_LOK
  s_cmp_eq_u64 vcc, -1
  s_cbranch_scc1 H_LOK
  s_sleep 1
  s_branch H_LW
H_LOK:
  ds_read_b128 v[20:23], v11 offset:16384
  ds_read_b128 v[24:27], v11 offset:17408
  ds_read_b128 v[28:31], v11 offset:18432
  ds_read_b128 v[32:35], v11 offset:19456
  ds_read_b128 v[36:39], v11 offset:20480
  ds_read_b128 v[40:43], v11 offset:21504
  ds_read_b128 v[44:47], v11 offset:22528
  ds_read_b128 v[48:51], v11 offset:23552
  ds_read_b128 v[52:55], v11 offset:24576
  ds_read_b128 v[56:59], v11 offset:25600
  s_waitcnt vmcnt(0)
  s_setprio 3
  s_cmp_lt_u32 s51, 4
  s_cbranch_scc1 H_SLOW
  v_mov_b32 v7, 0xff61b1e6
  v_mov_b32 v8, 0xff61b1e6
  s_waitcnt lgkmcnt(9)
  v_mfma_f32_32x32x16_bf16 v[124:139], v[20:23], v[12:15], v[76:91]
  s_waitcnt lgkmcnt(8)
  v_mfma_f32_32x32x16_bf16 v[140:155], v[24:27], v[12:15], 0
  v_mfma_f32_32x32x16_bf16 v[156:171], v[24:27], v[16:19], v[76:91]
  s_waitcnt lgkmcnt(7)
  v_mfma_f32_32x32x16_bf16 v[172:187], v[28:31], v[12:15], 0
  s_nop 7
  s_nop 0
  v_max3_f32 v7, v7, v124, v125
  v_max3_f32 v7, v7, v126, v127
  v_max3_f32 v7, v7, v128, v129
  v_max3_f32 v7, v7, v130, v131
  v_max3_f32 v7, v7, v132, v133
  v_max3_f32 v7, v7, v134, v135
  v_max3_f32 v7, v7, v136, v137
  v_max3_f32 v7, v7, v138, v139
  v_mfma_f32_32x32x16_bf16 v[124:139], v[28:31], v[16:19], 0
  v_max3_f32 v7, v7, v140, v141
  v_max3_f32 v7, v7, v142, v143
  v_max3_f32 v7, v7, v144, v145
  v_max3_f32 v7, v7, v146, v147
  v_max3_f32 v7, v7, v148, v149
  v_max3_f32 v7, v7, v150, v151
  v_max3_f32 v7, v7, v152, v153
  v_max3_f32 v7, v7, v154, v155
  s_waitcnt lgkmcnt(6)
  v_mfma_f32_32x32x16_bf16 v[140:155], v[32:35], v[12:15], 0
  s_nop 0
  v_max3_f32 v8, v8, v156, v157
  v_max3_f32 v8, v8, v158, v159
  v_max3_f32 v8, v8, v160, v161
  v_max3_f32 v8, v8, v162, v163
  v_max3_f32 v8, v8, v164, v165
  v_max3_f32 v8, v8, v166, v167
  v_max3_f32 v8, v8, v168, v169
  v_max3_f32 v8, v8, v170, v171
  v_mfma_f32_32x32x16_bf16 v[156:171], v[32:35], v[16:19], 0
  v_max3_f32 v7, v7, v172, v173
  v_max3_f32 v7, v7, v174, v175
  v_max3_f32 v7, v7, v176, v177
  v_max3_f32 v7, v7, v178, v179
  v_max3_f32 v7, v7, v180, v181
  v_max3_f32 v7, v7, v182, v183
  v_max3_f32 v7, v7, v184, v185
  v_max3_f32 v7, v7, v186, v187
  s_waitcnt lgkmcnt(5)
  v_mfma_f32_32x32x16_bf16 v[172:187], v[36:39], v[12:15], 0
  s_nop 0
  v_max3_f32 v8, v8, v124, v125
  v_max3_f32 v8, v8, v126, v127
  v_max3_f32 v8, v8, v128, v129
  v_max3_f32 v8, v8, v130, v131
  v_max3_f32 v8, v8, v132, v133
  v_max3_f32 v8, v8, v134, v135
  v_max3_f32 v8, v8, v136, v137
  v_max3_f32 v8, v8, v138, v139
  v_mfma_f32_32x32x16_bf16 v[124:139], v[36:39], v[16:19], 0
  v_max3_f32 v7, v7, v140, v141
  v_max3_f32 v7, v7, v142, v143
  v_max3_f32 v7, v7, v144, v145
  v_max3_f32 v7, v7, v146, v147
  v_max3_f32 v7, v7, v148, v149
  v_max3_f32 v7, v7, v150, v151
  v_max3_f32 v7, v7, v152, v153
  v_max3_f32 v7, v7, v154, v155
  s_waitcnt lgkmcnt(4)
  v_mfma_f32_32x32x16_bf16 v[140:155], v[40:43], v[12:15], 0
  s_nop 0
  v_max3_f32 v8, v8, v156, v157
  v_max3_f32 v8, v8, v158, v159
  v_max3_f32 v8, v8, v160, v161
  v_max3_f32 v8, v8, v162, v163
  v_max3_f32 v8, v8, v164, v165
  v_max3_f32 v8, v8, v166, v167
  v_max3_f32 v8, v8, v168, v169
  v_max3_f32 v8, v8, v170, v171
  v_mfma_f32_32x32x16_bf16 v[156:171], v[40:43], v[16:19], 0
  v_max3_f32 v7, v7, v172, v173
  v_max3_f32 v7, v7, v174, v175
  v_max3_f32 v7, v7, v176, v177
  v_max3_f32 v7, v7, v178, v179
  v_max3_f32 v7, v7, v180, v181
  v_max3_f32 v7, v7, v182, v183
  v_max3_f32 v7, v7, v184, v185
  v_max3_f32 v7, v7, v186, v187
  s_waitcnt lgkmcnt(3)
  v_mfma_f32_32x32x16_bf16 v[172:187], v[44:47], v[12:15], 0
  s_nop 0
  v_max3_f32 v8, v8, v124, v125
  v_max3_f32 v8, v8, v126, v127
  v_max3_f32 v8, v8, v128, v129
  v_max3_f32 v8, v8, v130, v131
  v_max3_f32 v8, v8, v132, v133
  v_max3_f32 v8, v8, v134, v135
  v_max3_f32 v8, v8, v136, v137
  v_max3_f32 v8, v8, v138, v139
  v_mfma_f32_32x32x16_bf16 v[124:139], v[44:47], v[16:19], 0
  v_max3_f32 v7, v7, v140, v141
  v_max3_f32 v7, v7, v142, v143
  v_max3_f32 v7, v7, v144, v145
  v_max3_f32 v7, v7, v146, v147
  v_max3_f32 v7, v7, v148, v149
  v_max3_f32 v7, v7, v150, v151
  v_max3_f32 v7, v7, v152, v153
  v_max3_f32 v7, v7, v154, v155
  s_waitcnt lgkmcnt(2)
  v_mfma_f32_32x32x16_bf16 v[140:155], v[48:51], v[12:15], 0
  s_nop 0
  v_max3_f32 v8, v8, v156, v157
  v_max3_f32 v8, v8, v158, v159
  v_max3_f32 v8, v8, v160, v161
  v_max3_f32 v8, v8, v162, v163
  v_max3_f32 v8, v8, v164, v165
  v_max3_f32 v8, v8, v166, v167
  v_max3_f32 v8, v8, v168, v169
  v_max3_f32 v8, v8, v170, v171
  v_mfma_f32_32x32x16_bf16 v[156:171], v[48:51], v[16:19], 0
  v_max3_f32 v7, v7, v172, v173
  v_max3_f32 v7, v7, v174, v175
  v_max3_f32 v7, v7, v176, v177
  v_max3_f32 v7, v7, v178, v179
  v_max3_f32 v7, v7, v180, v181
  v_max3_f32 v7, v7, v182, v183
  v_max3_f32 v7, v7, v184, v185
  v_max3_f32 v7, v7, v186, v187
  s_waitcnt lgkmcnt(1)
  v_mfma_f32_32x32x16_bf16 v[172:187], v[52:55], v[12:15], v[60:75]
  s_nop 0
  v_max3_f32 v8, v8, v124, v125
  v_max3_f32 v8, v8, v126, v127
  v_max3_f32 v8, v8, v128, v129
  v_max3_f32 v8, v8, v130, v131
  v_max3_f32 v8, v8, v132, v133
  v_max3_f32 v8, v8, v134, v135
  v_max3_f32 v8, v8, v136, v137
  v_max3_f32 v8, v8, v138, v139
  v_mfma_f32_32x32x16_bf16 v[124:139], v[52:55], v[16:19], 0
  v_max3_f32 v7, v7, v140, v141
  v_max3_f32 v7, v7, v142, v143
  v_max3_f32 v7, v7, v144, v145
  v_max3_f32 v7, v7, v146, v147
  v_max3_f32 v7, v7, v148, v149
  v_max3_f32 v7, v7, v150, v151
  v_max3_f32 v7, v7, v152, v153
  v_max3_f32 v7, v7, v154, v155
  s_waitcnt lgkmcnt(0)
  v_mfma_f32_32x32x16_bf16 v[140:155], v[56:59], v[16:19], v[60:75]
  s_nop 0
  v_max3_f32 v8, v8, v156, v157
  v_max3_f32 v8, v8, v158, v159
  v_max3_f32 v8, v8, v160, v161
  v_max3_f32 v8, v8, v162, v163
  v_max3_f32 v8, v8, v164, v165
  v_max3_f32 v8, v8, v166, v167
  v_max3_f32 v8, v8, v168, v169
  v_max3_f32 v8, v8, v170, v171
  s_nop 3
  s_nop 0
  v_max3_f32 v7, v7, v172, v173
  v_max3_f32 v7, v7, v174, v175
  v_max3_f32 v7, v7, v176, v177
  v_max3_f32 v7, v7, v178, v179
  v_max3_f32 v7, v7, v180, v181
  v_max3_f32 v7, v7, v182, v183
  v_max3_f32 v7, v7, v184, v185
  v_max3_f32 v7, v7, v186, v187
  s_nop 3
  s_nop 0
  v_max3_f32 v8, v8, v124, v125
  v_max3_f32 v8, v8, v126, v127
  v_max3_f32 v8, v8, v128, v129
  v_max3_f32 v8, v8, v130, v131
  v_max3_f32 v8, v8, v132, v133
  v_max3_f32 v8, v8, v134, v135
  v_max3_f32 v8, v8, v136, v137
  v_max3_f32 v8, v8, v138, v139
  s_nop 3
  s_nop 0
  v_max3_f32 v8, v8, v140, v141
  v_max3_f32 v8, v8, v142, v143
  v_max3_f32 v8, v8, v144, v145
  v_max3_f32 v8, v8, v146, v147
  v_max3_f32 v8, v8, v148, v149
  v_max3_f32 v8, v8, v150, v151
  v_max3_f32 v8, v8, v152, v153
  v_max3_f32 v8, v8, v154, v155
  v_mov_b32 v9, v7
  v_mov_b32 v10, v8
  s_nop 1
  v_permlane32_swap_b32 v9, v7
  v_permlane32_swap_b32 v10, v8
  s_nop 1
  v_max_f32 v7, v7, v9
  v_max_f32 v8, v8, v10
  v_sub_f32 v124, v76, v7
  v_sub_f32 v125, v77, v7
  v_sub_f32 v126, v78, v7
  v_sub_f32 v127, v79, v7
  v_sub_f32 v128, v80, v7
  v_sub_f32 v129, v81, v7
  v_sub_f32 v130, v82, v7
  v_sub_f32 v131, v83, v7
  v_sub_f32 v132, v84, v7
  v_sub_f32 v133, v85, v7
  v_sub_f32 v134, v86, v7
  v_sub_f32 v135, v87, v7
  v_sub_f32 v136, v88, v7
  v_sub_f32 v137, v89, v7
  v_sub_f32 v138, v90, v7
  v_sub_f32_e64 v139, v91, v7
  s_waitcnt lgkmcnt(0)
  ds_read_b64_tr_b16 v[204:205], v5 offset:0
  ds_read_b64_tr_b16 v[206:207], v5 offset:256
  ds_read_b64_tr_b16 v[208:209], v5 offset:512
  ds_read_b64_tr_b16 v[210:211], v5 offset:768
  v_add_u32_e64 v5, v6, v5
  v_mfma_f32_32x32x16_bf16 v[124:139], v[20:23], v[12:15], v[124:139]
  v_sub_f32 v92, 0, v7
  v_sub_f32 v93, 0, v7
  v_sub_f32 v94, 0, v7
  v_sub_f32 v95, 0, v7
  v_sub_f32 v96, 0, v7
  v_sub_f32 v97, 0, v7
  v_sub_f32 v98, 0, v7
  v_sub_f32 v99, 0, v7
  v_sub_f32 v100, 0, v7
  v_sub_f32 v101, 0, v7
  v_sub_f32 v102, 0, v7
  v_sub_f32 v103, 0, v7
  v_sub_f32 v104, 0, v7
  v_sub_f32 v105, 0, v7
  v_sub_f32 v106, 0, v7
  v_sub_f32 v107, 0, v7
  v_sub_f32 v108, 0, v8
  v_sub_f32 v109, 0, v8
  v_sub_f32 v110, 0, v8
  v_sub_f32 v111, 0, v8
  v_sub_f32 v112, 0, v8
  v_sub_f32 v113, 0, v8
  v_sub_f32 v114, 0, v8
  v_sub_f32 v115, 0, v8
  v_sub_f32 v116, 0, v8
  v_sub_f32 v117, 0, v8
  v_sub_f32 v118, 0, v8
  v_sub_f32 v119, 0, v8
  v_sub_f32 v120, 0, v8
  v_sub_f32 v121, 0, v8
  v_sub_f32 v122, 0, v8
  v_sub_f32 v123, 0, v8
  v_mfma_f32_32x32x16_bf16 v[140:155], v[24:27], v[12:15], v[92:107]
  v_exp_f32 v124, v124
  v_exp_f32 v125, v125
  v_exp_f32 v126, v126
  v_exp_f32 v127, v127
  v_exp_f32 v128, v128
  v_exp_f32 v129, v129
  v_exp_f32 v130, v130
  v_exp_f32 v131, v131
  v_exp_f32 v132, v132
  v_exp_f32 v133, v133
  v_exp_f32 v134, v134
  v_exp_f32 v135, v135
  v_exp_f32 v136, v136
  v_exp_f32 v137, v137
  v_exp_f32 v138, v138
  v_exp_f32 v139, v139
  ds_read_b64_tr_b16 v[212:213], v5 offset:0
  ds_read_b64_tr_b16 v[214:215], v5 offset:256
  ds_read_b64_tr_b16 v[216:217], v5 offset:512
  ds_read_b64_tr_b16 v[218:219], v5 offset:768
  v_add_u32_e64 v5, v6, v5
  v_cvt_pk_bf16_f32 v188, v124, v125
  v_cvt_pk_bf16_f32 v189, v126, v127
  v_cvt_pk_bf16_f32 v190, v128, v129
  v_cvt_pk_bf16_f32 v191, v130, v131
  v_cvt_pk_bf16_f32 v192, v132, v133
  v_cvt_pk_bf16_f32 v193, v134, v135
  v_cvt_pk_bf16_f32 v194, v136, v137
  v_cvt_pk_bf16_f32 v195, v138, v139
  v_sub_f32 v156, v76, v8
  v_sub_f32 v157, v77, v8
  v_sub_f32 v158, v78, v8
  v_sub_f32 v159, v79, v8
  v_sub_f32 v160, v80, v8
  v_sub_f32 v161, v81, v8
  v_sub_f32 v162, v82, v8
  v_sub_f32 v163, v83, v8
  v_sub_f32 v164, v84, v8
  v_sub_f32 v165, v85, v8
  v_sub_f32 v166, v86, v8
  v_sub_f32 v167, v87, v8
  v_sub_f32 v168, v88, v8
  v_sub_f32 v169, v89, v8
  v_sub_f32 v170, v90, v8
  v_sub_f32_e64 v171, v91, v8
  s_nop 1
  v_mfma_f32_32x32x16_bf16 v[156:171], v[24:27], v[16:19], v[156:171]
  v_exp_f32 v140, v140
  v_exp_f32 v141, v141
  v_exp_f32 v142, v142
  v_exp_f32 v143, v143
  v_exp_f32 v144, v144
  v_exp_f32_e64 v145, v145
  s_waitcnt lgkmcnt(0)
  v_mfma_f32_32x32x16_bf16 v[220:235], v[204:207], v[188:191], 0
  v_exp_f32 v146, v146
  v_exp_f32 v147, v147
  v_exp_f32 v148, v148
  v_exp_f32 v149, v149
  v_exp_f32 v150, v150
  v_exp_f32 v151, v151
  v_mfma_f32_32x32x16_bf16 v[220:235], v[208:211], v[192:195], v[220:235]
  v_exp_f32 v152, v152
  v_exp_f32 v153, v153
  v_exp_f32 v154, v154
  v_exp_f32 v155, v155
  v_cvt_pk_bf16_f32 v196, v140, v141
  v_cvt_pk_bf16_f32 v197, v142, v143
  v_cvt_pk_bf16_f32 v198, v144, v145
  v_cvt_pk_bf16_f32 v199, v146, v147
  v_cvt_pk_bf16_f32 v200, v148, v149
  v_cvt_pk_bf16_f32 v201, v150, v151
  v_cvt_pk_bf16_f32 v202, v152, v153
  v_cvt_pk_bf16_f32 v203, v154, v155
  v_mfma_f32_32x32x16_bf16 v[124:139], v[28:31], v[12:15], v[92:107]
  v_exp_f32 v156, v156
  v_exp_f32 v157, v157
  v_exp_f32 v158, v158
  v_exp_f32 v159, v159
  v_exp_f32 v160, v160
  v_exp_f32_e64 v161, v161
  s_waitcnt lgkmcnt(0)
  v_mfma_f32_32x32x16_bf16 v[220:235], v[212:215], v[196:199], v[220:235]
  v_exp_f32 v162, v162
  v_exp_f32 v163, v163
  v_exp_f32 v164, v164
  v_exp_f32 v165, v165
  v_exp_f32 v166, v166
  v_exp_f32 v167, v167
  v_mfma_f32_32x32x16_bf16 v[220:235], v[216:219], v[200:203], v[220:235]
  v_exp_f32 v168, v168
  v_exp_f32 v169, v169
  v_exp_f32 v170, v170
  v_exp_f32 v171, v171
  ds_read_b64_tr_b16 v[204:205], v5 offset:0
  ds_read_b64_tr_b16 v[206:207], v5 offset:256
  ds_read_b64_tr_b16 v[208:209], v5 offset:512
  ds_read_b64_tr_b16 v[210:211], v5 offset:768
  v_add_u32_e64 v5, v6, v5
  v_cvt_pk_bf16_f32 v188, v156, v157
  v_cvt_pk_bf16_f32 v189, v158, v159
  v_cvt_pk_bf16_f32 v190, v160, v161
  v_cvt_pk_bf16_f32 v191, v162, v163
  v_cvt_pk_bf16_f32 v192, v164, v165
  v_cvt_pk_bf16_f32 v193, v166, v167
  v_cvt_pk_bf16_f32 v194, v168, v169
  v_cvt_pk_bf16_f32 v195, v170, v171
  v_mfma_f32_32x32x16_bf16 v[140:155], v[28:31], v[16:19], v[108:123]
  v_exp_f32 v124, v124
  v_exp_f32 v125, v125
  v_exp_f32 v126, v126
  v_exp_f32 v127, v127
  v_exp_f32 v128, v128
  v_exp_f32 v129, v129
  v_mfma_f32_32x32x16_bf16 v[236:251], v[212:215], v[188:191], 0
  v_exp_f32 v130, v130
  v_exp_f32 v131, v131
  v_exp_f32 v132, v132
  v_exp_f32 v133, v133
  v_exp_f32 v134, v134
  v_exp_f32 v135, v135
  v_mfma_f32_32x32x16_bf16 v[236:251], v[216:219], v[192:195], v[236:251]
  v_exp_f32 v136, v136
  v_exp_f32 v137, v137
  v_exp_f32 v138, v138
  v_exp_f32 v139, v139
  v_cvt_pk_bf16_f32 v196, v124, v125
  v_cvt_pk_bf16_f32 v197, v126, v127
  v_cvt_pk_bf16_f32 v198, v128, v129
  v_cvt_pk_bf16_f32 v199, v130, v131
  v_cvt_pk_bf16_f32 v200, v132, v133
  v_cvt_pk_bf16_f32 v201, v134, v135
  v_cvt_pk_bf16_f32 v202, v136, v137
  v_cvt_pk_bf16_f32 v203, v138, v139
  v_mfma_f32_32x32x16_bf16 v[156:171], v[32:35], v[12:15], v[92:107]
  v_exp_f32 v140, v140
  v_exp_f32 v141, v141
  v_exp_f32 v142, v142
  v_exp_f32 v143, v143
  v_exp_f32 v144, v144
  v_exp_f32_e64 v145, v145
  s_waitcnt lgkmcnt(0)
  v_mfma_f32_32x32x16_bf16 v[220:235], v[204:207], v[196:199], v[220:235]
  v_exp_f32 v146, v146
  v_exp_f32 v147, v147
  v_exp_f32 v148, v148
  v_exp_f32 v149, v149
  v_exp_f32 v150, v150
  v_exp_f32 v151, v151
  v_mfma_f32_32x32x16_bf16 v[220:235], v[208:211], v[200:203], v[220:235]
  v_exp_f32 v152, v152
  v_exp_f32 v153, v153
  v_exp_f32 v154, v154
  v_exp_f32 v155, v155
  ds_read_b64_tr_b16 v[212:213], v5 offset:0
  ds_read_b64_tr_b16 v[214:215], v5 offset:256
  ds_read_b64_tr_b16 v[216:217], v5 offset:512
  ds_read_b64_tr_b16 v[218:219], v5 offset:768
  v_add_u32_e64 v5, v6, v5
  v_cvt_pk_bf16_f32 v188, v140, v141
  v_cvt_pk_bf16_f32 v189, v142, v143
  v_cvt_pk_bf16_f32 v190, v144, v145
  v_cvt_pk_bf16_f32 v191, v146, v147
  v_cvt_pk_bf16_f32 v192, v148, v149
  v_cvt_pk_bf16_f32 v193, v150, v151
  v_cvt_pk_bf16_f32 v194, v152, v153
  v_cvt_pk_bf16_f32 v195, v154, v155
  v_mfma_f32_32x32x16_bf16 v[124:139], v[32:35], v[16:19], v[108:123]
  v_exp_f32 v156, v156
  v_exp_f32 v157, v157
  v_exp_f32 v158, v158
  v_exp_f32 v159, v159
  v_exp_f32 v160, v160
  v_exp_f32 v161, v161
  v_mfma_f32_32x32x16_bf16 v[236:251], v[204:207], v[188:191], v[236:251]
  v_exp_f32 v162, v162
  v_exp_f32 v163, v163
  v_exp_f32 v164, v164
  v_exp_f32 v165, v165
  v_exp_f32 v166, v166
  v_exp_f32 v167, v167
  v_mfma_f32_32x32x16_bf16 v[236:251], v[208:211], v[192:195], v[236:251]
  v_exp_f32 v168, v168
  v_exp_f32 v169, v169
  v_exp_f32 v170, v170
  v_exp_f32 v171, v171
  v_cvt_pk_bf16_f32 v196, v156, v157
  v_cvt_pk_bf16_f32 v197, v158, v159
  v_cvt_pk_bf16_f32 v198, v160, v161
  v_cvt_pk_bf16_f32 v199, v162, v163
  v_cvt_pk_bf16_f32 v200, v164, v165
  v_cvt_pk_bf16_f32 v201, v166, v167
  v_cvt_pk_bf16_f32 v202, v168, v169
  v_cvt_pk_bf16_f32 v203, v170, v171
  v_mfma_f32_32x32x16_bf16 v[140:155], v[36:39], v[12:15], v[92:107]
  v_exp_f32 v124, v124
  v_exp_f32 v125, v125
  v_exp_f32 v126, v126
  v_exp_f32 v127, v127
  v_exp_f32 v128, v128
  v_exp_f32_e64 v129, v129
  s_waitcnt lgkmcnt(0)
  v_mfma_f32_32x32x16_bf16 v[220:235], v[212:215], v[196:199], v[220:235]
  v_exp_f32 v130, v130
  v_exp_f32 v131, v131
  v_exp_f32 v132, v132
  v_exp_f32 v133, v133
  v_exp_f32 v134, v134
  v_exp_f32 v135, v135
  v_mfma_f32_32x32x16_bf16 v[220:235], v[216:219], v[200:203], v[220:235]
  v_exp_f32 v136, v136
  v_exp_f32 v137, v137
  v_exp_f32 v138, v138
  v_exp_f32 v139, v139
  ds_read_b64_tr_b16 v[204:205], v5 offset:0
  ds_read_b64_tr_b16 v[206:207], v5 offset:256
  ds_read_b64_tr_b16 v[208:209], v5 offset:512
  ds_read_b64_tr_b16 v[210:211], v5 offset:768
  v_add_u32_e64 v5, v6, v5
  v_cvt_pk_bf16_f32 v188, v124, v125
  v_cvt_pk_bf16_f32 v189, v126, v127
  v_cvt_pk_bf16_f32 v190, v128, v129
  v_cvt_pk_bf16_f32 v191, v130, v131
  v_cvt_pk_bf16_f32 v192, v132, v133
  v_cvt_pk_bf16_f32 v193, v134, v135
  v_cvt_pk_bf16_f32 v194, v136, v137
  v_cvt_pk_bf16_f32 v195, v138, v139
  v_mfma_f32_32x32x16_bf16 v[156:171], v[36:39], v[16:19], v[108:123]
  v_exp_f32 v140, v140
  v_exp_f32 v141, v141
  v_exp_f32 v142, v142
  v_exp_f32 v143, v143
  v_exp_f32 v144, v144
  v_exp_f32 v145, v145
  v_mfma_f32_32x32x16_bf16 v[236:251], v[212:215], v[188:191], v[236:251]
  v_exp_f32 v146, v146
  v_exp_f32 v147, v147
  v_exp_f32 v148, v148
  v_exp_f32 v149, v149
  v_exp_f32 v150, v150
  v_exp_f32 v151, v151
  v_mfma_f32_32x32x16_bf16 v[236:251], v[216:219], v[192:195], v[236:251]
  v_exp_f32 v152, v152
  v_exp_f32 v153, v153
  v_exp_f32 v154, v154
  v_exp_f32 v155, v155
  v_cvt_pk_bf16_f32 v196, v140, v141
  v_cvt_pk_bf16_f32 v197, v142, v143
  v_cvt_pk_bf16_f32 v198, v144, v145
  v_cvt_pk_bf16_f32 v199, v146, v147
  v_cvt_pk_bf16_f32 v200, v148, v149
  v_cvt_pk_bf16_f32 v201, v150, v151
  v_cvt_pk_bf16_f32 v202, v152, v153
  v_cvt_pk_bf16_f32 v203, v154, v155
  v_mfma_f32_32x32x16_bf16 v[124:139], v[40:43], v[12:15], v[92:107]
  v_exp_f32 v156, v156
  v_exp_f32 v157, v157
  v_exp_f32 v158, v158
  v_exp_f32 v159, v159
  v_exp_f32 v160, v160
  v_exp_f32_e64 v161, v161
  s_waitcnt lgkmcnt(0)
  v_mfma_f32_32x32x16_bf16 v[220:235], v[204:207], v[196:199], v[220:235]
  v_exp_f32 v162, v162
  v_exp_f32 v163, v163
  v_exp_f32 v164, v164
  v_exp_f32 v165, v165
  v_exp_f32 v166, v166
  v_exp_f32 v167, v167
  v_mfma_f32_32x32x16_bf16 v[220:235], v[208:211], v[200:203], v[220:235]
  v_exp_f32 v168, v168
  v_exp_f32 v169, v169
  v_exp_f32 v170, v170
  v_exp_f32 v171, v171
  ds_read_b64_tr_b16 v[212:213], v5 offset:0
  ds_read_b64_tr_b16 v[214:215], v5 offset:256
  ds_read_b64_tr_b16 v[216:217], v5 offset:512
  ds_read_b64_tr_b16 v[218:219], v5 offset:768
  v_add_u32_e64 v5, v6, v5
  v_cvt_pk_bf16_f32 v188, v156, v157
  v_cvt_pk_bf16_f32 v189, v158, v159
  v_cvt_pk_bf16_f32 v190, v160, v161
  v_cvt_pk_bf16_f32 v191, v162, v163
  v_cvt_pk_bf16_f32 v192, v164, v165
  v_cvt_pk_bf16_f32 v193, v166, v167
  v_cvt_pk_bf16_f32 v194, v168, v169
  v_cvt_pk_bf16_f32 v195, v170, v171
  v_mfma_f32_32x32x16_bf16 v[140:155], v[40:43], v[16:19], v[108:123]
  v_exp_f32 v124, v124
  v_exp_f32 v125, v125
  v_exp_f32 v126, v126
  v_exp_f32 v127, v127
  v_exp_f32 v128, v128
  v_exp_f32 v129, v129
  v_mfma_f32_32x32x16_bf16 v[236:251], v[204:207], v[188:191], v[236:251]
  v_exp_f32 v130, v130
  v_exp_f32 v131, v131
  v_exp_f32 v132, v132
  v_exp_f32 v133, v133
  v_exp_f32 v134, v134
  v_exp_f32 v135, v135
  v_mfma_f32_32x32x16_bf16 v[236:251], v[208:211], v[192:195], v[236:251]
  v_exp_f32 v136, v136
  v_exp_f32 v137, v137
  v_exp_f32 v138, v138
  v_exp_f32 v139, v139
  v_cvt_pk_bf16_f32 v196, v124, v125
  v_cvt_pk_bf16_f32 v197, v126, v127
  v_cvt_pk_bf16_f32 v198, v128, v129
  v_cvt_pk_bf16_f32 v199, v130, v131
  v_cvt_pk_bf16_f32 v200, v132, v133
  v_cvt_pk_bf16_f32 v201, v134, v135
  v_cvt_pk_bf16_f32 v202, v136, v137
  v_cvt_pk_bf16_f32 v203, v138, v139
  v_mfma_f32_32x32x16_bf16 v[156:171], v[44:47], v[12:15], v[92:107]
  v_exp_f32 v140, v140
  v_exp_f32 v141, v141
  v_exp_f32 v142, v142
  v_exp_f32 v143, v143
  v_exp_f32 v144, v144
  v_exp_f32_e64 v145, v145
  s_waitcnt lgkmcnt(0)
  v_mfma_f32_32x32x16_bf16 v[220:235], v[212:215], v[196:199], v[220:235]
  v_exp_f32 v146, v146
  v_exp_f32 v147, v147
  v_exp_f32 v148, v148
  v_exp_f32 v149, v149
  v_exp_f32 v150, v150
  v_exp_f32 v151, v151
  v_mfma_f32_32x32x16_bf16 v[220:235], v[216:219], v[200:203], v[220:235]
  v_exp_f32 v152, v152
  v_exp_f32 v153, v153
  v_exp_f32 v154, v154
  v_exp_f32 v155, v155
  ds_read_b64_tr_b16 v[204:205], v5 offset:0
  ds_read_b64_tr_b16 v[206:207], v5 offset:256
  ds_read_b64_tr_b16 v[208:209], v5 offset:512
  ds_read_b64_tr_b16 v[210:211], v5 offset:768
  v_add_u32_e64 v5, v6, v5
  v_cvt_pk_bf16_f32 v188, v140, v141
  v_cvt_pk_bf16_f32 v189, v142, v143
  v_cvt_pk_bf16_f32 v190, v144, v145
  v_cvt_pk_bf16_f32 v191, v146, v147
  v_cvt_pk_bf16_f32 v192, v148, v149
  v_cvt_pk_bf16_f32 v193, v150, v151
  v_cvt_pk_bf16_f32 v194, v152, v153
  v_cvt_pk_bf16_f32 v195, v154, v155
  v_mfma_f32_32x32x16_bf16 v[124:139], v[44:47], v[16:19], v[108:123]
  v_exp_f32 v156, v156
  v_exp_f32 v157, v157
  v_exp_f32 v158, v158
  v_exp_f32 v159, v159
  v_exp_f32 v160, v160
  v_exp_f32 v161, v161
  v_mfma_f32_32x32x16_bf16 v[236:251], v[212:215], v[188:191], v[236:251]
  v_exp_f32 v162, v162
  v_exp_f32 v163, v163
  v_exp_f32 v164, v164
  v_exp_f32 v165, v165
  v_exp_f32 v166, v166
  v_exp_f32 v167, v167
  v_mfma_f32_32x32x16_bf16 v[236:251], v[216:219], v[192:195], v[236:251]
  v_exp_f32 v168, v168
  v_exp_f32 v169, v169
  v_exp_f32 v170, v170
  v_exp_f32 v171, v171
  v_cvt_pk_bf16_f32 v196, v156, v157
  v_cvt_pk_bf16_f32 v197, v158, v159
  v_cvt_pk_bf16_f32 v198, v160, v161
  v_cvt_pk_bf16_f32 v199, v162, v163
  v_cvt_pk_bf16_f32 v200, v164, v165
  v_cvt_pk_bf16_f32 v201, v166, v167
  v_cvt_pk_bf16_f32 v202, v168, v169
  v_cvt_pk_bf16_f32 v203, v170, v171
  v_mfma_f32_32x32x16_bf16 v[140:155], v[48:51], v[12:15], v[92:107]
  v_exp_f32 v124, v124
  v_exp_f32 v125, v125
  v_exp_f32 v126, v126
  v_exp_f32 v127, v127
  v_exp_f32 v128, v128
  v_exp_f32_e64 v129, v129
  s_waitcnt lgkmcnt(0)
  v_mfma_f32_32x32x16_bf16 v[220:235], v[204:207], v[196:199], v[220:235]
  v_exp_f32 v130, v130
  v_exp_f32 v131, v131
  v_exp_f32 v132, v132
  v_exp_f32 v133, v133
  v_exp_f32 v134, v134
  v_exp_f32 v135, v135
  v_mfma_f32_32x32x16_bf16 v[220:235], v[208:211], v[200:203], v[220:235]
  v_exp_f32 v136, v136
  v_exp_f32 v137, v137
  v_exp_f32 v138, v138
  v_exp_f32 v139, v139
  ds_read_b64_tr_b16 v[212:213], v5 offset:0
  ds_read_b64_tr_b16 v[214:215], v5 offset:256
  ds_read_b64_tr_b16 v[216:217], v5 offset:512
  ds_read_b64_tr_b16 v[218:219], v5 offset:768
  v_add_u32_e64 v5, v6, v5
  v_cvt_pk_bf16_f32 v188, v124, v125
  v_cvt_pk_bf16_f32 v189, v126, v127
  v_cvt_pk_bf16_f32 v190, v128, v129
  v_cvt_pk_bf16_f32 v191, v130, v131
  v_cvt_pk_bf16_f32 v192, v132, v133
  v_cvt_pk_bf16_f32 v193, v134, v135
  v_cvt_pk_bf16_f32 v194, v136, v137
  v_cvt_pk_bf16_f32 v195, v138, v139
  v_mfma_f32_32x32x16_bf16 v[156:171], v[48:51], v[16:19], v[108:123]
  v_exp_f32 v140, v140
  v_exp_f32 v141, v141
  v_exp_f32 v142, v142
  v_exp_f32 v143, v143
  v_exp_f32 v144, v144
  v_exp_f32 v145, v145
  v_mfma_f32_32x32x16_bf16 v[236:251], v[204:207], v[188:191], v[236:251]
  v_exp_f32 v146, v146
  v_exp_f32 v147, v147
  v_exp_f32 v148, v148
  v_exp_f32 v149, v149
  v_exp_f32 v150, v150
  v_exp_f32 v151, v151
  v_mfma_f32_32x32x16_bf16 v[236:251], v[208:211], v[192:195], v[236:251]
  v_exp_f32 v152, v152
  v_exp_f32 v153, v153
  v_exp_f32 v154, v154
  v_exp_f32 v155, v155
  v_cvt_pk_bf16_f32 v196, v140, v141
  v_cvt_pk_bf16_f32 v197, v142, v143
  v_cvt_pk_bf16_f32 v198, v144, v145
  v_cvt_pk_bf16_f32 v199, v146, v147
  v_cvt_pk_bf16_f32 v200, v148, v149
  v_cvt_pk_bf16_f32 v201, v150, v151
  v_cvt_pk_bf16_f32 v202, v152, v153
  v_cvt_pk_bf16_f32 v203, v154, v155
  v_sub_f32 v124, v60, v7
  v_sub_f32 v125, v61, v7
  v_sub_f32 v126, v62, v7
  v_sub_f32 v127, v63, v7
  v_sub_f32 v128, v64, v7
  v_sub_f32 v129, v65, v7
  v_sub_f32 v130, v66, v7
  v_sub_f32 v131, v67, v7
  v_sub_f32 v132, v68, v7
  v_sub_f32 v133, v69, v7
  v_sub_f32 v134, v70, v7
  v_sub_f32 v135, v71, v7
  v_sub_f32 v136, v72, v7
  v_sub_f32 v137, v73, v7
  v_sub_f32 v138, v74, v7
  v_sub_f32_e64 v139, v75, v7
  s_nop 1
  v_mfma_f32_32x32x16_bf16 v[124:139], v[52:55], v[12:15], v[124:139]
  v_exp_f32 v156, v156
  v_exp_f32 v157, v157
  v_exp_f32 v158, v158
  v_exp_f32 v159, v159
  v_exp_f32 v160, v160
  v_exp_f32_e64 v161, v161
  s_waitcnt lgkmcnt(0)
  v_mfma_f32_32x32x16_bf16 v[220:235], v[212:215], v[196:199], v[220:235]
  v_exp_f32 v162, v162
  v_exp_f32 v163, v163
  v_exp_f32 v164, v164
  v_exp_f32 v165, v165
  v_exp_f32 v166, v166
  v_exp_f32 v167, v167
  v_mfma_f32_32x32x16_bf16 v[220:235], v[216:219], v[200:203], v[220:235]
  v_exp_f32 v168, v168
  v_exp_f32 v169, v169
  v_exp_f32 v170, v170
  v_exp_f32 v171, v171
  ds_read_b64_tr_b16 v[204:205], v5 offset:0
  ds_read_b64_tr_b16 v[206:207], v5 offset:256
  ds_read_b64_tr_b16 v[208:209], v5 offset:512
  ds_read_b64_tr_b16 v[210:211], v5 offset:768
  v_add_u32_e64 v5, v6, v5
  v_cvt_pk_bf16_f32 v188, v156, v157
  v_cvt_pk_bf16_f32 v189, v158, v159
  v_cvt_pk_bf16_f32 v190, v160, v161
  v_cvt_pk_bf16_f32 v191, v162, v163
  v_cvt_pk_bf16_f32 v192, v164, v165
  v_cvt_pk_bf16_f32 v193, v166, v167
  v_cvt_pk_bf16_f32 v194, v168, v169
  v_cvt_pk_bf16_f32 v195, v170, v171
  v_mfma_f32_32x32x16_bf16 v[140:155], v[52:55], v[16:19], v[108:123]
  v_exp_f32 v124, v124
  v_exp_f32 v125, v125
  v_exp_f32 v126, v126
  v_exp_f32 v127, v127
  v_exp_f32 v128, v128
  v_exp_f32 v129, v129
  v_mfma_f32_32x32x16_bf16 v[236:251], v[212:215], v[188:191], v[236:251]
  v_exp_f32 v130, v130
  v_exp_f32 v131, v131
  v_exp_f32 v132, v132
  v_exp_f32 v133, v133
  v_exp_f32 v134, v134
  v_exp_f32 v135, v135
  v_mfma_f32_32x32x16_bf16 v[236:251], v[216:219], v[192:195], v[236:251]
  v_exp_f32 v136, v136
  v_exp_f32 v137, v137
  v_exp_f32 v138, v138
  v_exp_f32 v139, v139
  v_cvt_pk_bf16_f32 v196, v124, v125
  v_cvt_pk_bf16_f32 v197, v126, v127
  v_cvt_pk_bf16_f32 v198, v128, v129
  v_cvt_pk_bf16_f32 v199, v130, v131
  v_cvt_pk_bf16_f32 v200, v132, v133
  v_cvt_pk_bf16_f32 v201, v134, v135
  v_cvt_pk_bf16_f32 v202, v136, v137
  v_cvt_pk_bf16_f32 v203, v138, v139
  v_sub_f32 v156, v60, v8
  v_sub_f32 v157, v61, v8
  v_sub_f32 v158, v62, v8
  v_sub_f32 v159, v63, v8
  v_sub_f32 v160, v64, v8
  v_sub_f32 v161, v65, v8
  v_sub_f32 v162, v66, v8
  v_sub_f32 v163, v67, v8
  v_sub_f32 v164, v68, v8
  v_sub_f32 v165, v69, v8
  v_sub_f32 v166, v70, v8
  v_sub_f32 v167, v71, v8
  v_sub_f32 v168, v72, v8
  v_sub_f32 v169, v73, v8
  v_sub_f32 v170, v74, v8
  v_sub_f32_e64 v171, v75, v8
  s_nop 1
  v_mfma_f32_32x32x16_bf16 v[156:171], v[56:59], v[16:19], v[156:171]
  v_exp_f32 v140, v140
  v_exp_f32 v141, v141
  v_exp_f32 v142, v142
  v_exp_f32 v143, v143
  v_exp_f32 v144, v144
  v_exp_f32_e64 v145, v145
  s_waitcnt lgkmcnt(0)
  v_mfma_f32_32x32x16_bf16 v[220:235], v[204:207], v[196:199], v[220:235]
  v_exp_f32 v146, v146
  v_exp_f32 v147, v147
  v_exp_f32 v148, v148
  v_exp_f32 v149, v149
  v_exp_f32 v150, v150
  v_exp_f32 v151, v151
  v_mfma_f32_32x32x16_bf16 v[220:235], v[208:211], v[200:203], v[220:235]
  v_exp_f32 v152, v152
  v_exp_f32 v153, v153
  v_exp_f32 v154, v154
  v_exp_f32 v155, v155
  ds_read_b64_tr_b16 v[212:213], v5 offset:0
  ds_read_b64_tr_b16 v[214:215], v5 offset:256
  ds_read_b64_tr_b16 v[216:217], v5 offset:512
  ds_read_b64_tr_b16 v[218:219], v5 offset:768
  v_add_u32_e64 v5, v6, v5
  v_cvt_pk_bf16_f32 v188, v140, v141
  v_cvt_pk_bf16_f32 v189, v142, v143
  v_cvt_pk_bf16_f32 v190, v144, v145
  v_cvt_pk_bf16_f32 v191, v146, v147
  v_cvt_pk_bf16_f32 v192, v148, v149
  v_cvt_pk_bf16_f32 v193, v150, v151
  v_cvt_pk_bf16_f32 v194, v152, v153
  v_cvt_pk_bf16_f32 v195, v154, v155
  v_exp_f32 v156, v156
  v_exp_f32 v157, v157
  v_exp_f32 v158, v158
  v_exp_f32 v159, v159
  v_exp_f32 v160, v160
  v_exp_f32 v161, v161
  v_mfma_f32_32x32x16_bf16 v[236:251], v[204:207], v[188:191], v[236:251]
  v_exp_f32 v162, v162
  v_exp_f32 v163, v163
  v_exp_f32 v164, v164
  v_exp_f32 v165, v165
  v_exp_f32 v166, v166
  v_exp_f32 v167, v167
  v_mfma_f32_32x32x16_bf16 v[236:251], v[208:211], v[192:195], v[236:251]
  v_exp_f32 v168, v168
  v_exp_f32 v169, v169
  v_exp_f32 v170, v170
  v_exp_f32 v171, v171
  v_cvt_pk_bf16_f32 v196, v156, v157
  v_cvt_pk_bf16_f32 v197, v158, v159
  v_cvt_pk_bf16_f32 v198, v160, v161
  v_cvt_pk_bf16_f32 v199, v162, v163
  v_cvt_pk_bf16_f32 v200, v164, v165
  v_cvt_pk_bf16_f32 v201, v166, v167
  v_cvt_pk_bf16_f32 v202, v168, v169
  v_cvt_pk_bf16_f32 v203, v170, v171
  s_waitcnt lgkmcnt(0)
  s_nop 0
  v_mfma_f32_32x32x16_bf16 v[236:251], v[212:215], v[196:199], v[236:251]
  v_mfma_f32_32x32x16_bf16 v[236:251], v[216:219], v[200:203], v[236:251]
  s_lshl_b32 s52, s51, 16
  s_lshl_b32 s53, s50, 10
  s_add_u32 s52, s52, s53
  s_add_u32 s52, s52, 6291456
  s_add_u32 s53, s52, 32768
  v_rcp_f32 v9, v228
  s_nop 0
  v_mul_f32 v220, v220, v9
  v_mul_f32 v221, v221, v9
  v_mul_f32 v222, v222, v9
  v_mul_f32 v223, v223, v9
  v_mul_f32 v224, v224, v9
  v_mul_f32 v225, v225, v9
  v_mul_f32 v226, v226, v9
  v_mul_f32_e64 v227, v227, v9
  v_cvt_pk_bf16_f32 v228, v220, v221
  v_cvt_pk_bf16_f32 v229, v222, v223
  v_cvt_pk_bf16_f32 v230, v224, v225
  v_cvt_pk_bf16_f32 v231, v226, v227
  buffer_store_dwordx4 v[228:231], v3, s[20:23], s52 offen sc1
  s_nop 3
  v_rcp_f32 v9, v244
  s_nop 0
  v_mul_f32 v236, v236, v9
  v_mul_f32 v237, v237, v9
  v_mul_f32 v238, v238, v9
  v_mul_f32 v239, v239, v9
  v_mul_f32 v240, v240, v9
  v_mul_f32 v241, v241, v9
  v_mul_f32 v242, v242, v9
  v_mul_f32_e64 v243, v243, v9
  v_cvt_pk_bf16_f32 v244, v236, v237
  v_cvt_pk_bf16_f32 v245, v238, v239
  v_cvt_pk_bf16_f32 v246, v240, v241
  v_cvt_pk_bf16_f32 v247, v242, v243
  buffer_store_dwordx4 v[244:247], v3, s[20:23], s53 offen sc1
H_AFIN:
  s_lshl_b32 s57, s51, 12
  s_lshl_b32 s58, s50, 7
  s_add_u32 s57, s57, s58
  s_add_u32 s57, s57, 17825792
  v_mov_b32 v9, 0
  v_mov_b32_e64 v10, s80
  s_waitcnt vmcnt(0)
  s_mov_b64 exec, 1
  buffer_store_dword v10, v9, s[20:23], s57 offen sc1
  s_mov_b64 exec, -1
L_END:
  s_endpgm
H_GSLOW:
  s_mov_b32 s70, 0
H_GS1:
  s_add_u32 s59, s66, 0
  buffer_load_dwordx4 v[64:67], v16, s[20:23], s59 offen sc1
  s_add_u32 s59, s66, 5120
  buffer_load_dwordx4 v[68:71], v16, s[20:23], s59 offen sc1
  s_add_u32 s59, s66, 10240
  buffer_load_dwordx4 v[72:75], v16, s[20:23], s59 offen sc1
  s_add_u32 s59, s66, 15360
  buffer_load_dwordx4 v[76:79], v16, s[20:23], s59 offen sc1
  s_add_u32 s59, s66, 20480
  buffer_load_dwordx4 v[80:83], v16, s[20:23], s59 offen sc1
  s_add_u32 s59, s66, 25600
  buffer_load_dwordx4 v[84:87], v16, s[20:23], s59 offen sc1
  s_add_u32 s59, s66, 30720
  buffer_load_dwordx4 v[88:91], v16, s[20:23], s59 offen sc1
  s_add_u32 s59, s66, 35840
  buffer_load_dwordx4 v[92:95], v16, s[20:23], s59 offen sc1
  s_add_u32 s59, s66, 0
  buffer_load_dwordx4 v[96:99], v17, s[20:23], s59 offen sc1
  s_nop 0
  s_add_u32 s59, s66, 20480
  buffer_load_dwordx4 v[100:103], v17, s[20:23], s59 offen sc1
  buffer_load_dwordx4 v[104:107], v18, s[20:23], s67 offen sc1
  s_waitcnt vmcnt(0)
  v_and_b32 v19, v65, v67
  v_or_b32_e64 v20, v65, v67
  v_bitop3_b32 v19, v19, v69, v71 bitop3:0x80
  v_or3_b32 v20, v20, v69, v71
  v_bitop3_b32 v19, v19, v73, v75 bitop3:0x80
  v_or3_b32 v20, v20, v73, v75
  v_bitop3_b32 v19, v19, v77, v79 bitop3:0x80
  v_or3_b32 v20, v20, v77, v79
  v_bitop3_b32 v19, v19, v81, v83 bitop3:0x80
  v_or3_b32 v20, v20, v81, v83
  v_bitop3_b32 v19, v19, v85, v87 bitop3:0x80
  v_or3_b32 v20, v20, v85, v87
  v_bitop3_b32 v19, v19, v89, v91 bitop3:0x80
  v_or3_b32 v20, v20, v89, v91
  v_bitop3_b32 v19, v19, v93, v95 bitop3:0x80
  v_or3_b32 v20, v20, v93, v95
  v_bitop3_b32 v19, v19, v97, v99 bitop3:0x80
  v_or3_b32 v20, v20, v97, v99
  v_bitop3_b32 v19, v19, v101, v103 bitop3:0x80
  v_or3_b32 v20, v20, v101, v103
  v_and_b32 v19, v19, v106
  v_or_b32 v20, v20, v106
  v_xor_b32 v19, s80, v19
  v_xor_b32 v20, s80, v20
  v_or_b32 v19, v19, v20
  v_cmp_eq_u32 vcc, 0, v19
  s_nop 0
  s_cmp_eq_u64 vcc, -1
  s_cbranch_scc1 H_GS2
  s_add_u32 s70, s70, 1
  s_cmp_gt_u32 s70, 20000
  s_cbranch_scc1 H_GS2
  s_sleep 4
  s_branch H_GS1
H_GS2:
  v_add_f32 v64, v64, v68
  v_add_f32 v66, v66, v70
  v_add_f32 v72, v72, v76
  v_add_f32 v74, v74, v78
  v_add_f32 v80, v80, v84
  v_add_f32 v82, v82, v86
  v_add_f32 v88, v88, v92
  v_add_f32 v90, v90, v94
  v_add_f32 v64, v64, v72
  v_add_f32 v66, v66, v74
  v_add_f32 v80, v80, v88
  v_add_f32 v82, v82, v90
  v_add_f32 v64, v64, v80
  v_add_f32 v66, v66, v82
  v_add_f32 v96, v96, v100
  v_add_f32 v98, v98, v102
  v_mov_b32 v65, v64
  v_mov_b32_e64 v67, v66
  v_add_f32_dpp v96, v96, v96 row_ror:8 row_mask:0xf bank_mask:0xf
  v_add_f32_dpp v98, v98, v98 row_ror:8 row_mask:0xf bank_mask:0xf
  v_permlane32_swap_b32 v65, v64
  v_permlane32_swap_b32 v67, v66
  v_mov_b32 v97, v96
  v_mov_b32 v99, v98
  v_add_f32 v64, v64, v65
  v_add_f32 v66, v66, v67
  v_permlane32_swap_b32 v97, v96
  v_permlane32_swap_b32 v99, v98
  s_nop 0
  v_add_f32 v96, v96, v97
  v_add_f32 v98, v98, v99
  v_mov_b32 v97, v96
  v_mov_b32 v99, v98
  s_nop 1
  v_permlane16_swap_b32 v97, v96
  v_permlane16_swap_b32 v99, v98
  s_nop 0
  v_add_f32 v96, v96, v97
  v_add_f32_e64 v98, v98, v99
  v_cvt_pk_bf16_f32 v65, v64, v64
  v_and_b32 v65, 0xffff0000, v65
  v_sub_f32_e64 v64, v64, v65
  v_cvt_pk_bf16_f32 v68, v65, v64
  v_cvt_pk_bf16_f32 v67, v66, v66
  v_and_b32 v67, 0xffff0000, v67
  v_sub_f32_e64 v66, v66, v67
  v_cvt_pk_bf16_f32 v69, v67, v66
  v_cvt_pk_bf16_f32 v97, v96, v96
  v_and_b32 v97, 0xffff0000, v97
  v_sub_f32_e64 v96, v96, v97
  v_cvt_pk_bf16_f32 v70, v97, v96
  v_cvt_pk_bf16_f32 v99, v98, v98
  v_and_b32 v99, 0xffff0000, v99
  v_sub_f32_e64 v98, v98, v99
  v_cvt_pk_bf16_f32 v71, v99, v98
  v_lshrrev_b32 v16, 1, v18
  s_lshl_b32 s58, s15, 8
  s_add_u32 s58, s58, 155648
  v_add_u32_e64 v16, s58, v16
  ds_write_b64 v16, v[68:69]
  v_and_b32 v17, 7, v1
  v_lshlrev_b32_e64 v17, 3, v17
  s_lshl_b32 s58, s15, 6
  s_add_u32 s58, s58, 156672
  v_add_u32_e64 v17, s58, v17
  ds_write_b64 v17, v[70:71]
  s_branch H_GTOK
H_SLOW:
  s_lshl_b32 s56, s51, 1
  s_sub_u32 s56, 8, s56
  s_nop 0
  v_mov_b32 v92, 0xf149f2ca
  v_mov_b32 v93, 0xf149f2ca
  v_mov_b32 v94, 0xf149f2ca
  v_mov_b32 v95, 0xf149f2ca
  v_mov_b32 v96, 0xf149f2ca
  v_mov_b32 v97, 0xf149f2ca
  v_mov_b32 v98, 0xf149f2ca
  v_mov_b32 v99, 0xf149f2ca
  v_mov_b32 v100, 0xf149f2ca
  v_mov_b32 v101, 0xf149f2ca
  v_mov_b32 v102, 0xf149f2ca
  v_mov_b32 v103, 0xf149f2ca
  v_mov_b32 v104, 0xf149f2ca
  v_mov_b32 v105, 0xf149f2ca
  v_mov_b32 v106, 0xf149f2ca
  v_mov_b32 v107, 0xf149f2ca
  v_mov_b32 v7, 0xff61b1e6
  v_mov_b32 v8, 0xff61b1e6
  s_waitcnt lgkmcnt(9)
  s_cmp_gt_u32 s56, 0
  s_cbranch_scc1 AS_i1
  v_mfma_f32_32x32x16_bf16 v[124:139], v[20:23], v[12:15], v[76:91]
  s_branch AS_j1
AS_i1:
  v_mfma_f32_32x32x16_bf16 v[124:139], v[20:23], v[12:15], v[92:107]
AS_j1:
  s_waitcnt lgkmcnt(8)
  s_cmp_gt_u32 s56, 1
  s_cbranch_scc1 AS_i2
  v_mfma_f32_32x32x16_bf16 v[140:155], v[24:27], v[12:15], 0
  s_branch AS_j2
AS_i2:
  v_mfma_f32_32x32x16_bf16 v[140:155], v[24:27], v[12:15], v[92:107]
AS_j2:
  s_cmp_gt_u32 s56, 1
  s_cbranch_scc1 AS_i3
  v_mfma_f32_32x32x16_bf16 v[156:171], v[24:27], v[16:19], v[76:91]
  s_branch AS_j3
AS_i3:
  v_mfma_f32_32x32x16_bf16 v[156:171], v[24:27], v[16:19], v[92:107]
AS_j3:
  s_waitcnt lgkmcnt(7)
  s_cmp_gt_u32 s56, 2
  s_cbranch_scc1 AS_i4
  v_mfma_f32_32x32x16_bf16 v[172:187], v[28:31], v[12:15], 0
  s_branch AS_j4
AS_i4:
  v_mfma_f32_32x32x16_bf16 v[172:187], v[28:31], v[12:15], v[92:107]
AS_j4:
  s_nop 7
  v_max3_f32 v7, v7, v124, v125
  v_max3_f32 v7, v7, v126, v127
  v_max3_f32 v7, v7, v128, v129
  v_max3_f32 v7, v7, v130, v131
  v_max3_f32 v7, v7, v132, v133
  v_max3_f32 v7, v7, v134, v135
  v_max3_f32 v7, v7, v136, v137
  v_max3_f32 v7, v7, v138, v139
  s_cmp_gt_u32 s56, 2
  s_cbranch_scc1 AS_i5
  v_mfma_f32_32x32x16_bf16 v[124:139], v[28:31], v[16:19], 0
  s_branch AS_j5
AS_i5:
  v_mfma_f32_32x32x16_bf16 v[124:139], v[28:31], v[16:19], v[92:107]
AS_j5:
  s_nop 0
  v_max3_f32 v7, v7, v140, v141
  v_max3_f32 v7, v7, v142, v143
  v_max3_f32 v7, v7, v144, v145
  v_max3_f32 v7, v7, v146, v147
  v_max3_f32 v7, v7, v148, v149
  v_max3_f32 v7, v7, v150, v151
  v_max3_f32 v7, v7, v152, v153
  v_max3_f32 v7, v7, v154, v155
  s_waitcnt lgkmcnt(6)
  s_cmp_gt_u32 s56, 3
  s_cbranch_scc1 AS_i6
  v_mfma_f32_32x32x16_bf16 v[140:155], v[32:35], v[12:15], 0
  s_branch AS_j6
AS_i6:
  v_mfma_f32_32x32x16_bf16 v[140:155], v[32:35], v[12:15], v[92:107]
AS_j6:
  v_max3_f32 v8, v8, v156, v157
  v_max3_f32 v8, v8, v158, v159
  v_max3_f32 v8, v8, v160, v161
  v_max3_f32 v8, v8, v162, v163
  v_max3_f32 v8, v8, v164, v165
  v_max3_f32 v8, v8, v166, v167
  v_max3_f32 v8, v8, v168, v169
  v_max3_f32 v8, v8, v170, v171
  s_cmp_gt_u32 s56, 3
  s_cbranch_scc1 AS_i7
  v_mfma_f32_32x32x16_bf16 v[156:171], v[32:35], v[16:19], 0
  s_branch AS_j7
AS_i7:
  v_mfma_f32_32x32x16_bf16 v[156:171], v[32:35], v[16:19], v[92:107]
AS_j7:
  s_nop 0
  v_max3_f32 v7, v7, v172, v173
  v_max3_f32 v7, v7, v174, v175
  v_max3_f32 v7, v7, v176, v177
  v_max3_f32 v7, v7, v178, v179
  v_max3_f32 v7, v7, v180, v181
  v_max3_f32 v7, v7, v182, v183
  v_max3_f32 v7, v7, v184, v185
  v_max3_f32 v7, v7, v186, v187
  s_waitcnt lgkmcnt(5)
  s_cmp_gt_u32 s56, 4
  s_cbranch_scc1 AS_i8
  v_mfma_f32_32x32x16_bf16 v[172:187], v[36:39], v[12:15], 0
  s_branch AS_j8
AS_i8:
  v_mfma_f32_32x32x16_bf16 v[172:187], v[36:39], v[12:15], v[92:107]
AS_j8:
  v_max3_f32 v8, v8, v124, v125
  v_max3_f32 v8, v8, v126, v127
  v_max3_f32 v8, v8, v128, v129
  v_max3_f32 v8, v8, v130, v131
  v_max3_f32 v8, v8, v132, v133
  v_max3_f32 v8, v8, v134, v135
  v_max3_f32 v8, v8, v136, v137
  v_max3_f32 v8, v8, v138, v139
  s_cmp_gt_u32 s56, 4
  s_cbranch_scc1 AS_i9
  v_mfma_f32_32x32x16_bf16 v[124:139], v[36:39], v[16:19], 0
  s_branch AS_j9
AS_i9:
  v_mfma_f32_32x32x16_bf16 v[124:139], v[36:39], v[16:19], v[92:107]
AS_j9:
  s_nop 0
  v_max3_f32 v7, v7, v140, v141
  v_max3_f32 v7, v7, v142, v143
  v_max3_f32 v7, v7, v144, v145
  v_max3_f32 v7, v7, v146, v147
  v_max3_f32 v7, v7, v148, v149
  v_max3_f32 v7, v7, v150, v151
  v_max3_f32 v7, v7, v152, v153
  v_max3_f32 v7, v7, v154, v155
  s_waitcnt lgkmcnt(4)
  s_cmp_gt_u32 s56, 5
  s_cbranch_scc1 AS_i10
  v_mfma_f32_32x32x16_bf16 v[140:155], v[40:43], v[12:15], 0
  s_branch AS_j10
AS_i10:
  v_mfma_f32_32x32x16_bf16 v[140:155], v[40:43], v[12:15], v[92:107]
AS_j10:
  v_max3_f32 v8, v8, v156, v157
  v_max3_f32 v8, v8, v158, v159
  v_max3_f32 v8, v8, v160, v161
  v_max3_f32 v8, v8, v162, v163
  v_max3_f32 v8, v8, v164, v165
  v_max3_f32 v8, v8, v166, v167
  v_max3_f32 v8, v8, v168, v169
  v_max3_f32 v8, v8, v170, v171
  s_cmp_gt_u32 s56, 5
  s_cbranch_scc1 AS_i11
  v_mfma_f32_32x32x16_bf16 v[156:171], v[40:43], v[16:19], 0
  s_branch AS_j11
AS_i11:
  v_mfma_f32_32x32x16_bf16 v[156:171], v[40:43], v[16:19], v[92:107]
AS_j11:
  s_nop 0
  v_max3_f32 v7, v7, v172, v173
  v_max3_f32 v7, v7, v174, v175
  v_max3_f32 v7, v7, v176, v177
  v_max3_f32 v7, v7, v178, v179
  v_max3_f32 v7, v7, v180, v181
  v_max3_f32 v7, v7, v182, v183
  v_max3_f32 v7, v7, v184, v185
  v_max3_f32 v7, v7, v186, v187
  s_waitcnt lgkmcnt(3)
  s_cmp_gt_u32 s56, 6
  s_cbranch_scc1 AS_i12
  v_mfma_f32_32x32x16_bf16 v[172:187], v[44:47], v[12:15], 0
  s_branch AS_j12
AS_i12:
  v_mfma_f32_32x32x16_bf16 v[172:187], v[44:47], v[12:15], v[92:107]
AS_j12:
  v_max3_f32 v8, v8, v124, v125
  v_max3_f32 v8, v8, v126, v127
  v_max3_f32 v8, v8, v128, v129
  v_max3_f32 v8, v8, v130, v131
  v_max3_f32 v8, v8, v132, v133
  v_max3_f32 v8, v8, v134, v135
  v_max3_f32 v8, v8, v136, v137
  v_max3_f32 v8, v8, v138, v139
  s_cmp_gt_u32 s56, 6
  s_cbranch_scc1 AS_i13
  v_mfma_f32_32x32x16_bf16 v[124:139], v[44:47], v[16:19], 0
  s_branch AS_j13
AS_i13:
  v_mfma_f32_32x32x16_bf16 v[124:139], v[44:47], v[16:19], v[92:107]
AS_j13:
  s_nop 0
  v_max3_f32 v7, v7, v140, v141
  v_max3_f32 v7, v7, v142, v143
  v_max3_f32 v7, v7, v144, v145
  v_max3_f32 v7, v7, v146, v147
  v_max3_f32 v7, v7, v148, v149
  v_max3_f32 v7, v7, v150, v151
  v_max3_f32 v7, v7, v152, v153
  v_max3_f32 v7, v7, v154, v155
  s_waitcnt lgkmcnt(2)
  s_cmp_gt_u32 s56, 7
  s_cbranch_scc1 AS_i14
  v_mfma_f32_32x32x16_bf16 v[140:155], v[48:51], v[12:15], 0
  s_branch AS_j14
AS_i14:
  v_mfma_f32_32x32x16_bf16 v[140:155], v[48:51], v[12:15], v[92:107]
AS_j14:
  v_max3_f32 v8, v8, v156, v157
  v_max3_f32 v8, v8, v158, v159
  v_max3_f32 v8, v8, v160, v161
  v_max3_f32 v8, v8, v162, v163
  v_max3_f32 v8, v8, v164, v165
  v_max3_f32 v8, v8, v166, v167
  v_max3_f32 v8, v8, v168, v169
  v_max3_f32 v8, v8, v170, v171
  s_cmp_gt_u32 s56, 7
  s_cbranch_scc1 AS_i15
  v_mfma_f32_32x32x16_bf16 v[156:171], v[48:51], v[16:19], 0
  s_branch AS_j15
AS_i15:
  v_mfma_f32_32x32x16_bf16 v[156:171], v[48:51], v[16:19], v[92:107]
AS_j15:
  s_nop 0
  v_max3_f32 v7, v7, v172, v173
  v_max3_f32 v7, v7, v174, v175
  v_max3_f32 v7, v7, v176, v177
  v_max3_f32 v7, v7, v178, v179
  v_max3_f32 v7, v7, v180, v181
  v_max3_f32 v7, v7, v182, v183
  v_max3_f32 v7, v7, v184, v185
  v_max3_f32 v7, v7, v186, v187
  s_waitcnt lgkmcnt(1)
  v_mfma_f32_32x32x16_bf16 v[172:187], v[52:55], v[12:15], v[60:75]
  s_nop 0
  v_max3_f32 v8, v8, v124, v125
  v_max3_f32 v8, v8, v126, v127
  v_max3_f32 v8, v8, v128, v129
  v_max3_f32 v8, v8, v130, v131
  v_max3_f32 v8, v8, v132, v133
  v_max3_f32 v8, v8, v134, v135
  v_max3_f32 v8, v8, v136, v137
  v_max3_f32 v8, v8, v138, v139
  v_mfma_f32_32x32x16_bf16 v[124:139], v[52:55], v[16:19], 0
  v_max3_f32 v7, v7, v140, v141
  v_max3_f32 v7, v7, v142, v143
  v_max3_f32 v7, v7, v144, v145
  v_max3_f32 v7, v7, v146, v147
  v_max3_f32 v7, v7, v148, v149
  v_max3_f32 v7, v7, v150, v151
  v_max3_f32 v7, v7, v152, v153
  v_max3_f32 v7, v7, v154, v155
  s_waitcnt lgkmcnt(0)
  v_mfma_f32_32x32x16_bf16 v[140:155], v[56:59], v[16:19], v[60:75]
  s_nop 0
  v_max3_f32 v8, v8, v156, v157
  v_max3_f32 v8, v8, v158, v159
  v_max3_f32 v8, v8, v160, v161
  v_max3_f32 v8, v8, v162, v163
  v_max3_f32 v8, v8, v164, v165
  v_max3_f32 v8, v8, v166, v167
  v_max3_f32 v8, v8, v168, v169
  v_max3_f32 v8, v8, v170, v171
  s_nop 3
  s_nop 0
  v_max3_f32 v7, v7, v172, v173
  v_max3_f32 v7, v7, v174, v175
  v_max3_f32 v7, v7, v176, v177
  v_max3_f32 v7, v7, v178, v179
  v_max3_f32 v7, v7, v180, v181
  v_max3_f32 v7, v7, v182, v183
  v_max3_f32 v7, v7, v184, v185
  v_max3_f32 v7, v7, v186, v187
  s_nop 3
  s_nop 0
  v_max3_f32 v8, v8, v124, v125
  v_max3_f32 v8, v8, v126, v127
  v_max3_f32 v8, v8, v128, v129
  v_max3_f32 v8, v8, v130, v131
  v_max3_f32 v8, v8, v132, v133
  v_max3_f32 v8, v8, v134, v135
  v_max3_f32 v8, v8, v136, v137
  v_max3_f32 v8, v8, v138, v139
  s_nop 3
  s_nop 0
  v_max3_f32 v8, v8, v140, v141
  v_max3_f32 v8, v8, v142, v143
  v_max3_f32 v8, v8, v144, v145
  v_max3_f32 v8, v8, v146, v147
  v_max3_f32 v8, v8, v148, v149
  v_max3_f32 v8, v8, v150, v151
  v_max3_f32 v8, v8, v152, v153
  v_max3_f32 v8, v8, v154, v155
  v_mov_b32 v9, v7
  v_mov_b32 v10, v8
  s_nop 1
  v_permlane32_swap_b32 v9, v7
  v_permlane32_swap_b32 v10, v8
  s_nop 1
  v_max_f32 v7, v7, v9
  v_max_f32 v8, v8, v10
  v_sub_f32 v124, v76, v7
  v_sub_f32 v125, v77, v7
  v_sub_f32 v126, v78, v7
  v_sub_f32 v127, v79, v7
  v_sub_f32 v128, v80, v7
  v_sub_f32 v129, v81, v7
  v_sub_f32 v130, v82, v7
  v_sub_f32 v131, v83, v7
  v_sub_f32 v132, v84, v7
  v_sub_f32 v133, v85, v7
  v_sub_f32 v134, v86, v7
  v_sub_f32 v135, v87, v7
  v_sub_f32 v136, v88, v7
  v_sub_f32 v137, v89, v7
  v_sub_f32 v138, v90, v7
  v_sub_f32_e64 v139, v91, v7
  s_waitcnt lgkmcnt(0)
  ds_read_b64_tr_b16 v[204:205], v5 offset:0
  ds_read_b64_tr_b16 v[206:207], v5 offset:256
  ds_read_b64_tr_b16 v[208:209], v5 offset:512
  ds_read_b64_tr_b16 v[210:211], v5 offset:768
  v_add_u32_e64 v5, v6, v5
  v_mov_b32 v172, 0xf149f2ca
  v_mov_b32 v173, 0xf149f2ca
  v_mov_b32 v174, 0xf149f2ca
  v_mov_b32 v175, 0xf149f2ca
  v_mov_b32 v176, 0xf149f2ca
  v_mov_b32 v177, 0xf149f2ca
  v_mov_b32 v178, 0xf149f2ca
  v_mov_b32 v179, 0xf149f2ca
  v_mov_b32 v180, 0xf149f2ca
  v_mov_b32 v181, 0xf149f2ca
  v_mov_b32 v182, 0xf149f2ca
  v_mov_b32 v183, 0xf149f2ca
  v_mov_b32 v184, 0xf149f2ca
  v_mov_b32 v185, 0xf149f2ca
  v_mov_b32 v186, 0xf149f2ca
  v_mov_b32 v187, 0xf149f2ca
  s_cmp_gt_u32 s56, 0
  s_cbranch_scc1 AS_i16
  v_mfma_f32_32x32x16_bf16 v[124:139], v[20:23], v[12:15], v[124:139]
  s_branch AS_j16
AS_i16:
  v_mfma_f32_32x32x16_bf16 v[124:139], v[20:23], v[12:15], v[172:187]
AS_j16:
  v_sub_f32 v92, 0, v7
  v_sub_f32 v93, 0, v7
  v_sub_f32 v94, 0, v7
  v_sub_f32 v95, 0, v7
  v_sub_f32 v96, 0, v7
  v_sub_f32 v97, 0, v7
  v_sub_f32 v98, 0, v7
  v_sub_f32 v99, 0, v7
  v_sub_f32 v100, 0, v7
  v_sub_f32 v101, 0, v7
  v_sub_f32 v102, 0, v7
  v_sub_f32 v103, 0, v7
  v_sub_f32 v104, 0, v7
  v_sub_f32 v105, 0, v7
  v_sub_f32 v106, 0, v7
  v_sub_f32 v107, 0, v7
  v_sub_f32 v108, 0, v8
  v_sub_f32 v109, 0, v8
  v_sub_f32 v110, 0, v8
  v_sub_f32 v111, 0, v8
  v_sub_f32 v112, 0, v8
  v_sub_f32 v113, 0, v8
  v_sub_f32 v114, 0, v8
  v_sub_f32 v115, 0, v8
  v_sub_f32 v116, 0, v8
  v_sub_f32 v117, 0, v8
  v_sub_f32 v118, 0, v8
  v_sub_f32 v119, 0, v8
  v_sub_f32 v120, 0, v8
  v_sub_f32 v121, 0, v8
  v_sub_f32 v122, 0, v8
  v_sub_f32_e64 v123, 0, v8
  s_cmp_gt_u32 s56, 1
  s_cbranch_scc1 AS_i17
  v_mfma_f32_32x32x16_bf16 v[140:155], v[24:27], v[12:15], v[92:107]
  s_branch AS_j17
AS_i17:
  v_mfma_f32_32x32x16_bf16 v[140:155], v[24:27], v[12:15], v[172:187]
AS_j17:
  v_exp_f32 v124, v124
  v_exp_f32 v125, v125
  v_exp_f32 v126, v126
  v_exp_f32 v127, v127
  v_exp_f32 v128, v128
  v_exp_f32 v129, v129
  v_exp_f32 v130, v130
  v_exp_f32 v131, v131
  v_exp_f32 v132, v132
  v_exp_f32 v133, v133
  v_exp_f32 v134, v134
  v_exp_f32 v135, v135
  v_exp_f32 v136, v136
  v_exp_f32 v137, v137
  v_exp_f32 v138, v138
  v_exp_f32_e64 v139, v139
  ds_read_b64_tr_b16 v[212:213], v5 offset:0
  ds_read_b64_tr_b16 v[214:215], v5 offset:256
  ds_read_b64_tr_b16 v[216:217], v5 offset:512
  ds_read_b64_tr_b16 v[218:219], v5 offset:768
  v_add_u32_e64 v5, v6, v5
  v_cvt_pk_bf16_f32 v188, v124, v125
  v_cvt_pk_bf16_f32 v189, v126, v127
  v_cvt_pk_bf16_f32 v190, v128, v129
  v_cvt_pk_bf16_f32 v191, v130, v131
  v_cvt_pk_bf16_f32 v192, v132, v133
  v_cvt_pk_bf16_f32 v193, v134, v135
  v_cvt_pk_bf16_f32 v194, v136, v137
  v_cvt_pk_bf16_f32 v195, v138, v139
  v_sub_f32 v156, v76, v8
  v_sub_f32 v157, v77, v8
  v_sub_f32 v158, v78, v8
  v_sub_f32 v159, v79, v8
  v_sub_f32 v160, v80, v8
  v_sub_f32 v161, v81, v8
  v_sub_f32 v162, v82, v8
  v_sub_f32 v163, v83, v8
  v_sub_f32 v164, v84, v8
  v_sub_f32 v165, v85, v8
  v_sub_f32 v166, v86, v8
  v_sub_f32 v167, v87, v8
  v_sub_f32 v168, v88, v8
  v_sub_f32 v169, v89, v8
  v_sub_f32 v170, v90, v8
  v_sub_f32_e64 v171, v91, v8
  s_nop 1
  s_cmp_gt_u32 s56, 1
  s_cbranch_scc1 AS_i18
  v_mfma_f32_32x32x16_bf16 v[156:171], v[24:27], v[16:19], v[156:171]
  s_branch AS_j18
AS_i18:
  v_mfma_f32_32x32x16_bf16 v[156:171], v[24:27], v[16:19], v[172:187]
AS_j18:
  v_exp_f32 v140, v140
  v_exp_f32 v141, v141
  v_exp_f32 v142, v142
  v_exp_f32 v143, v143
  v_exp_f32 v144, v144
  v_exp_f32 v145, v145
  s_waitcnt lgkmcnt(0)
  v_mfma_f32_32x32x16_bf16 v[220:235], v[204:207], v[188:191], 0
  v_exp_f32 v146, v146
  v_exp_f32 v147, v147
  v_exp_f32 v148, v148
  v_exp_f32 v149, v149
  v_exp_f32 v150, v150
  v_exp_f32 v151, v151
  v_mfma_f32_32x32x16_bf16 v[220:235], v[208:211], v[192:195], v[220:235]
  v_exp_f32 v152, v152
  v_exp_f32 v153, v153
  v_exp_f32 v154, v154
  v_exp_f32 v155, v155
  v_cvt_pk_bf16_f32 v196, v140, v141
  v_cvt_pk_bf16_f32 v197, v142, v143
  v_cvt_pk_bf16_f32 v198, v144, v145
  v_cvt_pk_bf16_f32 v199, v146, v147
  v_cvt_pk_bf16_f32 v200, v148, v149
  v_cvt_pk_bf16_f32 v201, v150, v151
  v_cvt_pk_bf16_f32 v202, v152, v153
  v_cvt_pk_bf16_f32 v203, v154, v155
  s_cmp_gt_u32 s56, 2
  s_cbranch_scc1 AS_i19
  v_mfma_f32_32x32x16_bf16 v[124:139], v[28:31], v[12:15], v[92:107]
  s_branch AS_j19
AS_i19:
  v_mfma_f32_32x32x16_bf16 v[124:139], v[28:31], v[12:15], v[172:187]
AS_j19:
  v_exp_f32 v156, v156
  v_exp_f32 v157, v157
  v_exp_f32 v158, v158
  v_exp_f32 v159, v159
  v_exp_f32 v160, v160
  v_exp_f32 v161, v161
  s_waitcnt lgkmcnt(0)
  v_mfma_f32_32x32x16_bf16 v[220:235], v[212:215], v[196:199], v[220:235]
  v_exp_f32 v162, v162
  v_exp_f32 v163, v163
  v_exp_f32 v164, v164
  v_exp_f32 v165, v165
  v_exp_f32 v166, v166
  v_exp_f32 v167, v167
  v_mfma_f32_32x32x16_bf16 v[220:235], v[216:219], v[200:203], v[220:235]
  v_exp_f32 v168, v168
  v_exp_f32 v169, v169
  v_exp_f32 v170, v170
  v_exp_f32 v171, v171
  ds_read_b64_tr_b16 v[204:205], v5 offset:0
  ds_read_b64_tr_b16 v[206:207], v5 offset:256
  ds_read_b64_tr_b16 v[208:209], v5 offset:512
  ds_read_b64_tr_b16 v[210:211], v5 offset:768
  v_add_u32_e64 v5, v6, v5
  v_cvt_pk_bf16_f32 v188, v156, v157
  v_cvt_pk_bf16_f32 v189, v158, v159
  v_cvt_pk_bf16_f32 v190, v160, v161
  v_cvt_pk_bf16_f32 v191, v162, v163
  v_cvt_pk_bf16_f32 v192, v164, v165
  v_cvt_pk_bf16_f32 v193, v166, v167
  v_cvt_pk_bf16_f32 v194, v168, v169
  v_cvt_pk_bf16_f32 v195, v170, v171
  s_cmp_gt_u32 s56, 2
  s_cbranch_scc1 AS_i20
  v_mfma_f32_32x32x16_bf16 v[140:155], v[28:31], v[16:19], v[108:123]
  s_branch AS_j20
AS_i20:
  v_mfma_f32_32x32x16_bf16 v[140:155], v[28:31], v[16:19], v[172:187]
AS_j20:
  v_exp_f32 v124, v124
  v_exp_f32 v125, v125
  v_exp_f32 v126, v126
  v_exp_f32 v127, v127
  v_exp_f32 v128, v128
  v_exp_f32_e64 v129, v129
  v_mfma_f32_32x32x16_bf16 v[236:251], v[212:215], v[188:191], 0
  v_exp_f32 v130, v130
  v_exp_f32 v131, v131
  v_exp_f32 v132, v132
  v_exp_f32 v133, v133
  v_exp_f32 v134, v134
  v_exp_f32 v135, v135
  v_mfma_f32_32x32x16_bf16 v[236:251], v[216:219], v[192:195], v[236:251]
  v_exp_f32 v136, v136
  v_exp_f32 v137, v137
  v_exp_f32 v138, v138
  v_exp_f32 v139, v139
  v_cvt_pk_bf16_f32 v196, v124, v125
  v_cvt_pk_bf16_f32 v197, v126, v127
  v_cvt_pk_bf16_f32 v198, v128, v129
  v_cvt_pk_bf16_f32 v199, v130, v131
  v_cvt_pk_bf16_f32 v200, v132, v133
  v_cvt_pk_bf16_f32 v201, v134, v135
  v_cvt_pk_bf16_f32 v202, v136, v137
  v_cvt_pk_bf16_f32 v203, v138, v139
  s_cmp_gt_u32 s56, 3
  s_cbranch_scc1 AS_i21
  v_mfma_f32_32x32x16_bf16 v[156:171], v[32:35], v[12:15], v[92:107]
  s_branch AS_j21
AS_i21:
  v_mfma_f32_32x32x16_bf16 v[156:171], v[32:35], v[12:15], v[172:187]
AS_j21:
  v_exp_f32 v140, v140
  v_exp_f32 v141, v141
  v_exp_f32 v142, v142
  v_exp_f32 v143, v143
  v_exp_f32 v144, v144
  v_exp_f32 v145, v145
  s_waitcnt lgkmcnt(0)
  v_mfma_f32_32x32x16_bf16 v[220:235], v[204:207], v[196:199], v[220:235]
  v_exp_f32 v146, v146
  v_exp_f32 v147, v147
  v_exp_f32 v148, v148
  v_exp_f32 v149, v149
  v_exp_f32 v150, v150
  v_exp_f32 v151, v151
  v_mfma_f32_32x32x16_bf16 v[220:235], v[208:211], v[200:203], v[220:235]
  v_exp_f32 v152, v152
  v_exp_f32 v153, v153
  v_exp_f32 v154, v154
  v_exp_f32 v155, v155
  ds_read_b64_tr_b16 v[212:213], v5 offset:0
  ds_read_b64_tr_b16 v[214:215], v5 offset:256
  ds_read_b64_tr_b16 v[216:217], v5 offset:512
  ds_read_b64_tr_b16 v[218:219], v5 offset:768
  v_add_u32_e64 v5, v6, v5
  v_cvt_pk_bf16_f32 v188, v140, v141
  v_cvt_pk_bf16_f32 v189, v142, v143
  v_cvt_pk_bf16_f32 v190, v144, v145
  v_cvt_pk_bf16_f32 v191, v146, v147
  v_cvt_pk_bf16_f32 v192, v148, v149
  v_cvt_pk_bf16_f32 v193, v150, v151
  v_cvt_pk_bf16_f32 v194, v152, v153
  v_cvt_pk_bf16_f32 v195, v154, v155
  s_cmp_gt_u32 s56, 3
  s_cbranch_scc1 AS_i22
  v_mfma_f32_32x32x16_bf16 v[124:139], v[32:35], v[16:19], v[108:123]
  s_branch AS_j22
AS_i22:
  v_mfma_f32_32x32x16_bf16 v[124:139], v[32:35], v[16:19], v[172:187]
AS_j22:
  v_exp_f32 v156, v156
  v_exp_f32 v157, v157
  v_exp_f32 v158, v158
  v_exp_f32 v159, v159
  v_exp_f32 v160, v160
  v_exp_f32_e64 v161, v161
  v_mfma_f32_32x32x16_bf16 v[236:251], v[204:207], v[188:191], v[236:251]
  v_exp_f32 v162, v162
  v_exp_f32 v163, v163
  v_exp_f32 v164, v164
  v_exp_f32 v165, v165
  v_exp_f32 v166, v166
  v_exp_f32 v167, v167
  v_mfma_f32_32x32x16_bf16 v[236:251], v[208:211], v[192:195], v[236:251]
  v_exp_f32 v168, v168
  v_exp_f32 v169, v169
  v_exp_f32 v170, v170
  v_exp_f32 v171, v171
  v_cvt_pk_bf16_f32 v196, v156, v157
  v_cvt_pk_bf16_f32 v197, v158, v159
  v_cvt_pk_bf16_f32 v198, v160, v161
  v_cvt_pk_bf16_f32 v199, v162, v163
  v_cvt_pk_bf16_f32 v200, v164, v165
  v_cvt_pk_bf16_f32 v201, v166, v167
  v_cvt_pk_bf16_f32 v202, v168, v169
  v_cvt_pk_bf16_f32 v203, v170, v171
  s_cmp_gt_u32 s56, 4
  s_cbranch_scc1 AS_i23
  v_mfma_f32_32x32x16_bf16 v[140:155], v[36:39], v[12:15], v[92:107]
  s_branch AS_j23
AS_i23:
  v_mfma_f32_32x32x16_bf16 v[140:155], v[36:39], v[12:15], v[172:187]
AS_j23:
  v_exp_f32 v124, v124
  v_exp_f32 v125, v125
  v_exp_f32 v126, v126
  v_exp_f32 v127, v127
  v_exp_f32 v128, v128
  v_exp_f32 v129, v129
  s_waitcnt lgkmcnt(0)
  v_mfma_f32_32x32x16_bf16 v[220:235], v[212:215], v[196:199], v[220:235]
  v_exp_f32 v130, v130
  v_exp_f32 v131, v131
  v_exp_f32 v132, v132
  v_exp_f32 v133, v133
  v_exp_f32 v134, v134
  v_exp_f32 v135, v135
  v_mfma_f32_32x32x16_bf16 v[220:235], v[216:219], v[200:203], v[220:235]
  v_exp_f32 v136, v136
  v_exp_f32 v137, v137
  v_exp_f32 v138, v138
  v_exp_f32 v139, v139
  ds_read_b64_tr_b16 v[204:205], v5 offset:0
  ds_read_b64_tr_b16 v[206:207], v5 offset:256
  ds_read_b64_tr_b16 v[208:209], v5 offset:512
  ds_read_b64_tr_b16 v[210:211], v5 offset:768
  v_add_u32_e64 v5, v6, v5
  v_cvt_pk_bf16_f32 v188, v124, v125
  v_cvt_pk_bf16_f32 v189, v126, v127
  v_cvt_pk_bf16_f32 v190, v128, v129
  v_cvt_pk_bf16_f32 v191, v130, v131
  v_cvt_pk_bf16_f32 v192, v132, v133
  v_cvt_pk_bf16_f32 v193, v134, v135
  v_cvt_pk_bf16_f32 v194, v136, v137
  v_cvt_pk_bf16_f32 v195, v138, v139
  s_cmp_gt_u32 s56, 4
  s_cbranch_scc1 AS_i24
  v_mfma_f32_32x32x16_bf16 v[156:171], v[36:39], v[16:19], v[108:123]
  s_branch AS_j24
AS_i24:
  v_mfma_f32_32x32x16_bf16 v[156:171], v[36:39], v[16:19], v[172:187]
AS_j24:
  v_exp_f32 v140, v140
  v_exp_f32 v141, v141
  v_exp_f32 v142, v142
  v_exp_f32 v143, v143
  v_exp_f32 v144, v144
  v_exp_f32_e64 v145, v145
  v_mfma_f32_32x32x16_bf16 v[236:251], v[212:215], v[188:191], v[236:251]
  v_exp_f32 v146, v146
  v_exp_f32 v147, v147
  v_exp_f32 v148, v148
  v_exp_f32 v149, v149
  v_exp_f32 v150, v150
  v_exp_f32 v151, v151
  v_mfma_f32_32x32x16_bf16 v[236:251], v[216:219], v[192:195], v[236:251]
  v_exp_f32 v152, v152
  v_exp_f32 v153, v153
  v_exp_f32 v154, v154
  v_exp_f32 v155, v155
  v_cvt_pk_bf16_f32 v196, v140, v141
  v_cvt_pk_bf16_f32 v197, v142, v143
  v_cvt_pk_bf16_f32 v198, v144, v145
  v_cvt_pk_bf16_f32 v199, v146, v147
  v_cvt_pk_bf16_f32 v200, v148, v149
  v_cvt_pk_bf16_f32 v201, v150, v151
  v_cvt_pk_bf16_f32 v202, v152, v153
  v_cvt_pk_bf16_f32 v203, v154, v155
  s_cmp_gt_u32 s56, 5
  s_cbranch_scc1 AS_i25
  v_mfma_f32_32x32x16_bf16 v[124:139], v[40:43], v[12:15], v[92:107]
  s_branch AS_j25
AS_i25:
  v_mfma_f32_32x32x16_bf16 v[124:139], v[40:43], v[12:15], v[172:187]
AS_j25:
  v_exp_f32 v156, v156
  v_exp_f32 v157, v157
  v_exp_f32 v158, v158
  v_exp_f32 v159, v159
  v_exp_f32 v160, v160
  v_exp_f32 v161, v161
  s_waitcnt lgkmcnt(0)
  v_mfma_f32_32x32x16_bf16 v[220:235], v[204:207], v[196:199], v[220:235]
  v_exp_f32 v162, v162
  v_exp_f32 v163, v163
  v_exp_f32 v164, v164
  v_exp_f32 v165, v165
  v_exp_f32 v166, v166
  v_exp_f32 v167, v167
  v_mfma_f32_32x32x16_bf16 v[220:235], v[208:211], v[200:203], v[220:235]
  v_exp_f32 v168, v168
  v_exp_f32 v169, v169
  v_exp_f32 v170, v170
  v_exp_f32 v171, v171
  ds_read_b64_tr_b16 v[212:213], v5 offset:0
  ds_read_b64_tr_b16 v[214:215], v5 offset:256
  ds_read_b64_tr_b16 v[216:217], v5 offset:512
  ds_read_b64_tr_b16 v[218:219], v5 offset:768
  v_add_u32_e64 v5, v6, v5
  v_cvt_pk_bf16_f32 v188, v156, v157
  v_cvt_pk_bf16_f32 v189, v158, v159
  v_cvt_pk_bf16_f32 v190, v160, v161
  v_cvt_pk_bf16_f32 v191, v162, v163
  v_cvt_pk_bf16_f32 v192, v164, v165
  v_cvt_pk_bf16_f32 v193, v166, v167
  v_cvt_pk_bf16_f32 v194, v168, v169
  v_cvt_pk_bf16_f32 v195, v170, v171
  s_cmp_gt_u32 s56, 5
  s_cbranch_scc1 AS_i26
  v_mfma_f32_32x32x16_bf16 v[140:155], v[40:43], v[16:19], v[108:123]
  s_branch AS_j26
AS_i26:
  v_mfma_f32_32x32x16_bf16 v[140:155], v[40:43], v[16:19], v[172:187]
AS_j26:
  v_exp_f32 v124, v124
  v_exp_f32 v125, v125
  v_exp_f32 v126, v126
  v_exp_f32 v127, v127
  v_exp_f32 v128, v128
  v_exp_f32_e64 v129, v129
  v_mfma_f32_32x32x16_bf16 v[236:251], v[204:207], v[188:191], v[236:251]
  v_exp_f32 v130, v130
  v_exp_f32 v131, v131
  v_exp_f32 v132, v132
  v_exp_f32 v133, v133
  v_exp_f32 v134, v134
  v_exp_f32 v135, v135
  v_mfma_f32_32x32x16_bf16 v[236:251], v[208:211], v[192:195], v[236:251]
  v_exp_f32 v136, v136
  v_exp_f32 v137, v137
  v_exp_f32 v138, v138
  v_exp_f32 v139, v139
  v_cvt_pk_bf16_f32 v196, v124, v125
  v_cvt_pk_bf16_f32 v197, v126, v127
  v_cvt_pk_bf16_f32 v198, v128, v129
  v_cvt_pk_bf16_f32 v199, v130, v131
  v_cvt_pk_bf16_f32 v200, v132, v133
  v_cvt_pk_bf16_f32 v201, v134, v135
  v_cvt_pk_bf16_f32 v202, v136, v137
  v_cvt_pk_bf16_f32 v203, v138, v139
  s_cmp_gt_u32 s56, 6
  s_cbranch_scc1 AS_i27
  v_mfma_f32_32x32x16_bf16 v[156:171], v[44:47], v[12:15], v[92:107]
  s_branch AS_j27
AS_i27:
  v_mfma_f32_32x32x16_bf16 v[156:171], v[44:47], v[12:15], v[172:187]
AS_j27:
  v_exp_f32 v140, v140
  v_exp_f32 v141, v141
  v_exp_f32 v142, v142
  v_exp_f32 v143, v143
  v_exp_f32 v144, v144
  v_exp_f32 v145, v145
  s_waitcnt lgkmcnt(0)
  v_mfma_f32_32x32x16_bf16 v[220:235], v[212:215], v[196:199], v[220:235]
  v_exp_f32 v146, v146
  v_exp_f32 v147, v147
  v_exp_f32 v148, v148
  v_exp_f32 v149, v149
  v_exp_f32 v150, v150
  v_exp_f32 v151, v151
  v_mfma_f32_32x32x16_bf16 v[220:235], v[216:219], v[200:203], v[220:235]
  v_exp_f32 v152, v152
  v_exp_f32 v153, v153
  v_exp_f32 v154, v154
  v_exp_f32 v155, v155
  ds_read_b64_tr_b16 v[204:205], v5 offset:0
  ds_read_b64_tr_b16 v[206:207], v5 offset:256
  ds_read_b64_tr_b16 v[208:209], v5 offset:512
  ds_read_b64_tr_b16 v[210:211], v5 offset:768
  v_add_u32_e64 v5, v6, v5
  v_cvt_pk_bf16_f32 v188, v140, v141
  v_cvt_pk_bf16_f32 v189, v142, v143
  v_cvt_pk_bf16_f32 v190, v144, v145
  v_cvt_pk_bf16_f32 v191, v146, v147
  v_cvt_pk_bf16_f32 v192, v148, v149
  v_cvt_pk_bf16_f32 v193, v150, v151
  v_cvt_pk_bf16_f32 v194, v152, v153
  v_cvt_pk_bf16_f32 v195, v154, v155
  s_cmp_gt_u32 s56, 6
  s_cbranch_scc1 AS_i28
  v_mfma_f32_32x32x16_bf16 v[124:139], v[44:47], v[16:19], v[108:123]
  s_branch AS_j28
AS_i28:
  v_mfma_f32_32x32x16_bf16 v[124:139], v[44:47], v[16:19], v[172:187]
AS_j28:
  v_exp_f32 v156, v156
  v_exp_f32 v157, v157
  v_exp_f32 v158, v158
  v_exp_f32 v159, v159
  v_exp_f32 v160, v160
  v_exp_f32_e64 v161, v161
  v_mfma_f32_32x32x16_bf16 v[236:251], v[212:215], v[188:191], v[236:251]
  v_exp_f32 v162, v162
  v_exp_f32 v163, v163
  v_exp_f32 v164, v164
  v_exp_f32 v165, v165
  v_exp_f32 v166, v166
  v_exp_f32 v167, v167
  v_mfma_f32_32x32x16_bf16 v[236:251], v[216:219], v[192:195], v[236:251]
  v_exp_f32 v168, v168
  v_exp_f32 v169, v169
  v_exp_f32 v170, v170
  v_exp_f32 v171, v171
  v_cvt_pk_bf16_f32 v196, v156, v157
  v_cvt_pk_bf16_f32 v197, v158, v159
  v_cvt_pk_bf16_f32 v198, v160, v161
  v_cvt_pk_bf16_f32 v199, v162, v163
  v_cvt_pk_bf16_f32 v200, v164, v165
  v_cvt_pk_bf16_f32 v201, v166, v167
  v_cvt_pk_bf16_f32 v202, v168, v169
  v_cvt_pk_bf16_f32 v203, v170, v171
  s_cmp_gt_u32 s56, 7
  s_cbranch_scc1 AS_i29
  v_mfma_f32_32x32x16_bf16 v[140:155], v[48:51], v[12:15], v[92:107]
  s_branch AS_j29
AS_i29:
  v_mfma_f32_32x32x16_bf16 v[140:155], v[48:51], v[12:15], v[172:187]
AS_j29:
  v_exp_f32 v124, v124
  v_exp_f32 v125, v125
  v_exp_f32 v126, v126
  v_exp_f32 v127, v127
  v_exp_f32 v128, v128
  v_exp_f32 v129, v129
  s_waitcnt lgkmcnt(0)
  v_mfma_f32_32x32x16_bf16 v[220:235], v[204:207], v[196:199], v[220:235]
  v_exp_f32 v130, v130
  v_exp_f32 v131, v131
  v_exp_f32 v132, v132
  v_exp_f32 v133, v133
  v_exp_f32 v134, v134
  v_exp_f32 v135, v135
  v_mfma_f32_32x32x16_bf16 v[220:235], v[208:211], v[200:203], v[220:235]
  v_exp_f32 v136, v136
  v_exp_f32 v137, v137
  v_exp_f32 v138, v138
  v_exp_f32 v139, v139
  ds_read_b64_tr_b16 v[212:213], v5 offset:0
  ds_read_b64_tr_b16 v[214:215], v5 offset:256
  ds_read_b64_tr_b16 v[216:217], v5 offset:512
  ds_read_b64_tr_b16 v[218:219], v5 offset:768
  v_add_u32_e64 v5, v6, v5
  v_cvt_pk_bf16_f32 v188, v124, v125
  v_cvt_pk_bf16_f32 v189, v126, v127
  v_cvt_pk_bf16_f32 v190, v128, v129
  v_cvt_pk_bf16_f32 v191, v130, v131
  v_cvt_pk_bf16_f32 v192, v132, v133
  v_cvt_pk_bf16_f32 v193, v134, v135
  v_cvt_pk_bf16_f32 v194, v136, v137
  v_cvt_pk_bf16_f32 v195, v138, v139
  s_cmp_gt_u32 s56, 7
  s_cbranch_scc1 AS_i30
  v_mfma_f32_32x32x16_bf16 v[156:171], v[48:51], v[16:19], v[108:123]
  s_branch AS_j30
AS_i30:
  v_mfma_f32_32x32x16_bf16 v[156:171], v[48:51], v[16:19], v[172:187]
AS_j30:
  v_exp_f32 v140, v140
  v_exp_f32 v141, v141
  v_exp_f32 v142, v142
  v_exp_f32 v143, v143
  v_exp_f32 v144, v144
  v_exp_f32_e64 v145, v145
  v_mfma_f32_32x32x16_bf16 v[236:251], v[204:207], v[188:191], v[236:251]
  v_exp_f32 v146, v146
  v_exp_f32 v147, v147
  v_exp_f32 v148, v148
  v_exp_f32 v149, v149
  v_exp_f32 v150, v150
  v_exp_f32 v151, v151
  v_mfma_f32_32x32x16_bf16 v[236:251], v[208:211], v[192:195], v[236:251]
  v_exp_f32 v152, v152
  v_exp_f32 v153, v153
  v_exp_f32 v154, v154
  v_exp_f32 v155, v155
  v_cvt_pk_bf16_f32 v196, v140, v141
  v_cvt_pk_bf16_f32 v197, v142, v143
  v_cvt_pk_bf16_f32 v198, v144, v145
  v_cvt_pk_bf16_f32 v199, v146, v147
  v_cvt_pk_bf16_f32 v200, v148, v149
  v_cvt_pk_bf16_f32 v201, v150, v151
  v_cvt_pk_bf16_f32 v202, v152, v153
  v_cvt_pk_bf16_f32 v203, v154, v155
  v_sub_f32 v124, v60, v7
  v_sub_f32 v125, v61, v7
  v_sub_f32 v126, v62, v7
  v_sub_f32 v127, v63, v7
  v_sub_f32 v128, v64, v7
  v_sub_f32 v129, v65, v7
  v_sub_f32 v130, v66, v7
  v_sub_f32 v131, v67, v7
  v_sub_f32 v132, v68, v7
  v_sub_f32 v133, v69, v7
  v_sub_f32 v134, v70, v7
  v_sub_f32 v135, v71, v7
  v_sub_f32 v136, v72, v7
  v_sub_f32 v137, v73, v7
  v_sub_f32 v138, v74, v7
  v_sub_f32_e64 v139, v75, v7
  s_nop 1
  v_mfma_f32_32x32x16_bf16 v[124:139], v[52:55], v[12:15], v[124:139]
  v_exp_f32 v156, v156
  v_exp_f32 v157, v157
  v_exp_f32 v158, v158
  v_exp_f32 v159, v159
  v_exp_f32 v160, v160
  v_exp_f32_e64 v161, v161
  s_waitcnt lgkmcnt(0)
  v_mfma_f32_32x32x16_bf16 v[220:235], v[212:215], v[196:199], v[220:235]
  v_exp_f32 v162, v162
  v_exp_f32 v163, v163
  v_exp_f32 v164, v164
  v_exp_f32 v165, v165
  v_exp_f32 v166, v166
  v_exp_f32 v167, v167
  v_mfma_f32_32x32x16_bf16 v[220:235], v[216:219], v[200:203], v[220:235]
  v_exp_f32 v168, v168
  v_exp_f32 v169, v169
  v_exp_f32 v170, v170
  v_exp_f32 v171, v171
  ds_read_b64_tr_b16 v[204:205], v5 offset:0
  ds_read_b64_tr_b16 v[206:207], v5 offset:256
  ds_read_b64_tr_b16 v[208:209], v5 offset:512
  ds_read_b64_tr_b16 v[210:211], v5 offset:768
  v_add_u32_e64 v5, v6, v5
  v_cvt_pk_bf16_f32 v188, v156, v157
  v_cvt_pk_bf16_f32 v189, v158, v159
  v_cvt_pk_bf16_f32 v190, v160, v161
  v_cvt_pk_bf16_f32 v191, v162, v163
  v_cvt_pk_bf16_f32 v192, v164, v165
  v_cvt_pk_bf16_f32 v193, v166, v167
  v_cvt_pk_bf16_f32 v194, v168, v169
  v_cvt_pk_bf16_f32 v195, v170, v171
  v_mfma_f32_32x32x16_bf16 v[140:155], v[52:55], v[16:19], v[108:123]
  v_exp_f32 v124, v124
  v_exp_f32 v125, v125
  v_exp_f32 v126, v126
  v_exp_f32 v127, v127
  v_exp_f32 v128, v128
  v_exp_f32 v129, v129
  v_mfma_f32_32x32x16_bf16 v[236:251], v[212:215], v[188:191], v[236:251]
  v_exp_f32 v130, v130
  v_exp_f32 v131, v131
  v_exp_f32 v132, v132
  v_exp_f32 v133, v133
  v_exp_f32 v134, v134
  v_exp_f32 v135, v135
  v_mfma_f32_32x32x16_bf16 v[236:251], v[216:219], v[192:195], v[236:251]
  v_exp_f32 v136, v136
  v_exp_f32 v137, v137
  v_exp_f32 v138, v138
  v_exp_f32 v139, v139
  v_cvt_pk_bf16_f32 v196, v124, v125
  v_cvt_pk_bf16_f32 v197, v126, v127
  v_cvt_pk_bf16_f32 v198, v128, v129
  v_cvt_pk_bf16_f32 v199, v130, v131
  v_cvt_pk_bf16_f32 v200, v132, v133
  v_cvt_pk_bf16_f32 v201, v134, v135
  v_cvt_pk_bf16_f32 v202, v136, v137
  v_cvt_pk_bf16_f32 v203, v138, v139
  v_sub_f32 v156, v60, v8
  v_sub_f32 v157, v61, v8
  v_sub_f32 v158, v62, v8
  v_sub_f32 v159, v63, v8
  v_sub_f32 v160, v64, v8
  v_sub_f32 v161, v65, v8
  v_sub_f32 v162, v66, v8
  v_sub_f32 v163, v67, v8
  v_sub_f32 v164, v68, v8
  v_sub_f32 v165, v69, v8
  v_sub_f32 v166, v70, v8
  v_sub_f32 v167, v71, v8
  v_sub_f32 v168, v72, v8
  v_sub_f32 v169, v73, v8
  v_sub_f32 v170, v74, v8
  v_sub_f32_e64 v171, v75, v8
  s_nop 1
  v_mfma_f32_32x32x16_bf16 v[156:171], v[56:59], v[16:19], v[156:171]
  v_exp_f32 v140, v140
  v_exp_f32 v141, v141
  v_exp_f32 v142, v142
  v_exp_f32 v143, v143
  v_exp_f32 v144, v144
  v_exp_f32_e64 v145, v145
  s_waitcnt lgkmcnt(0)
  v_mfma_f32_32x32x16_bf16 v[220:235], v[204:207], v[196:199], v[220:235]
  v_exp_f32 v146, v146
  v_exp_f32 v147, v147
  v_exp_f32 v148, v148
  v_exp_f32 v149, v149
  v_exp_f32 v150, v150
  v_exp_f32 v151, v151
  v_mfma_f32_32x32x16_bf16 v[220:235], v[208:211], v[200:203], v[220:235]
  v_exp_f32 v152, v152
  v_exp_f32 v153, v153
  v_exp_f32 v154, v154
  v_exp_f32 v155, v155
  ds_read_b64_tr_b16 v[212:213], v5 offset:0
  ds_read_b64_tr_b16 v[214:215], v5 offset:256
  ds_read_b64_tr_b16 v[216:217], v5 offset:512
  ds_read_b64_tr_b16 v[218:219], v5 offset:768
  v_add_u32_e64 v5, v6, v5
  v_cvt_pk_bf16_f32 v188, v140, v141
  v_cvt_pk_bf16_f32 v189, v142, v143
  v_cvt_pk_bf16_f32 v190, v144, v145
  v_cvt_pk_bf16_f32 v191, v146, v147
  v_cvt_pk_bf16_f32 v192, v148, v149
  v_cvt_pk_bf16_f32 v193, v150, v151
  v_cvt_pk_bf16_f32 v194, v152, v153
  v_cvt_pk_bf16_f32 v195, v154, v155
  v_exp_f32 v156, v156
  v_exp_f32 v157, v157
  v_exp_f32 v158, v158
  v_exp_f32 v159, v159
  v_exp_f32 v160, v160
  v_exp_f32 v161, v161
  v_mfma_f32_32x32x16_bf16 v[236:251], v[204:207], v[188:191], v[236:251]
  v_exp_f32 v162, v162
  v_exp_f32 v163, v163
  v_exp_f32 v164, v164
  v_exp_f32 v165, v165
  v_exp_f32 v166, v166
  v_exp_f32 v167, v167
  v_mfma_f32_32x32x16_bf16 v[236:251], v[208:211], v[192:195], v[236:251]
  v_exp_f32 v168, v168
  v_exp_f32 v169, v169
  v_exp_f32 v170, v170
  v_exp_f32 v171, v171
  v_cvt_pk_bf16_f32 v196, v156, v157
  v_cvt_pk_bf16_f32 v197, v158, v159
  v_cvt_pk_bf16_f32 v198, v160, v161
  v_cvt_pk_bf16_f32 v199, v162, v163
  v_cvt_pk_bf16_f32 v200, v164, v165
  v_cvt_pk_bf16_f32 v201, v166, v167
  v_cvt_pk_bf16_f32 v202, v168, v169
  v_cvt_pk_bf16_f32 v203, v170, v171
  s_waitcnt lgkmcnt(0)
  s_nop 0
  v_mfma_f32_32x32x16_bf16 v[236:251], v[212:215], v[196:199], v[236:251]
  v_mfma_f32_32x32x16_bf16 v[236:251], v[216:219], v[200:203], v[236:251]
  s_lshl_b32 s52, s51, 16
  s_lshl_b32 s53, s50, 10
  s_add_u32 s52, s52, s53
  s_add_u32 s52, s52, 6291456
  s_add_u32 s53, s52, 32768
  v_rcp_f32 v9, v228
  s_nop 0
  v_mul_f32 v220, v220, v9
  v_mul_f32 v221, v221, v9
  v_mul_f32 v222, v222, v9
  v_mul_f32 v223, v223, v9
  v_mul_f32 v224, v224, v9
  v_mul_f32 v225, v225, v9
  v_mul_f32 v226, v226, v9
  v_mul_f32_e64 v227, v227, v9
  v_cvt_pk_bf16_f32 v228, v220, v221
  v_cvt_pk_bf16_f32 v229, v222, v223
  v_cvt_pk_bf16_f32 v230, v224, v225
  v_cvt_pk_bf16_f32 v231, v226, v227
  buffer_store_dwordx4 v[228:231], v3, s[20:23], s52 offen sc1
  s_nop 3
  v_rcp_f32 v9, v244
  s_nop 0
  v_mul_f32 v236, v236, v9
  v_mul_f32 v237, v237, v9
  v_mul_f32 v238, v238, v9
  v_mul_f32 v239, v239, v9
  v_mul_f32 v240, v240, v9
  v_mul_f32 v241, v241, v9
  v_mul_f32 v242, v242, v9
  v_mul_f32_e64 v243, v243, v9
  v_cvt_pk_bf16_f32 v244, v236, v237
  v_cvt_pk_bf16_f32 v245, v238, v239
  v_cvt_pk_bf16_f32 v246, v240, v241
  v_cvt_pk_bf16_f32 v247, v242, v243
  buffer_store_dwordx4 v[244:247], v3, s[20:23], s53 offen sc1
  s_branch H_AFIN
L_M:
  s_waitcnt lgkmcnt(0)
  s_mov_b32 s20, s18
  s_mov_b32 s21, s19
  s_mov_b32 s22, 0x10000000
  s_mov_b32 s23, 0x20000
  s_mov_b32 s18, 256
  s_mov_b32 s19, 0x20000
  s_getpc_b64 s[24:25]
L_PC:
  s_sub_u32 s24, s24, L_PC-recurrent_scan__sliding_block__geglu_ffn__prompt_kernel
  s_subb_u32 s25, s25, 0
  s_mov_b32 s26, L_CODE_END-recurrent_scan__sliding_block__geglu_ffn__prompt_kernel
  s_mov_b32 s27, 0x20000
  s_lshr_b32 s57, s2, 3
  s_lshl_b32 s57, s57, 2
  s_add_u32 s57, s57, s14
  s_lshl_b32 s57, s57, 9
  v_lshlrev_b32 v16, 7, v1
  s_mov_b64 exec, 15
  buffer_load_dword v31, v16, s[24:27], s57 offen
  s_mov_b64 exec, -1
  s_setprio 2
  s_and_b32 s12, s14, 1
  s_lshr_b32 s13, s14, 1
  v_and_b32 v16, 31, v1
  v_lshrrev_b32 v17, 5, v1
  v_bfe_u32 v18, v1, 1, 3
  v_xor_b32 v17, v17, v18
  v_lshlrev_b32 v17, 4, v17
  v_lshlrev_b32 v16, 7, v16
  v_add_u32 v16, v16, v17
  s_lshl_b32 s57, s12, 13
  v_add_u32 v2, s57, v16
  v_xor_b32 v3, 32, v2
  v_xor_b32 v4, 64, v2
  v_xor_b32 v5, 96, v2
  v_lshrrev_b32 v16, 5, v1
  v_lshlrev_b32 v16, 10, v16
  v_bfe_u32 v17, v1, 2, 2
  v_lshlrev_b32 v17, 6, v17
  v_add_u32 v16, v16, v17
  v_and_b32 v17, 3, v1
  v_lshlrev_b32 v17, 3, v17
  v_add_u32_e64 v16, v16, v17
  v_add_u32 v16, 49152, v16
  v_bfe_u32 v17, v1, 4, 1
  s_sub_u32 s57, 2, s50
  s_lshl_b32 s57, s57, 12
  v_mul_u32_u24 v18, s57, v17
  v_xor_b32 v19, s13, v17
  v_lshlrev_b32_e64 v19, 5, v19
  v_add3_u32 v18, v18, v19, v16
  v_lshlrev_b32 v19, 5, v17
  s_lshl_b32 s57, s13, 9
  v_add3_u32 v19, v19, s57, v16
  s_cmp_eq_u32 s50, 1
  s_cselect_b64 vcc, -1, 0
  v_add_u32_e64 v6, 0, v18
  v_add_u32 v7, 512, v18
  v_add_u32 v20, 4096, v18
  v_add_u32 v21, 8192, v19
  v_cndmask_b32 v8, v20, v21, vcc
  v_add_u32 v20, 4608, v18
  v_add_u32 v21, 12288, v19
  v_cndmask_b32 v9, v20, v21, vcc
  v_add_u32 v10, 16384, v19
  v_add_u32 v11, 81920, v6
  v_add_u32 v12, 81920, v7
  v_add_u32 v13, 81920, v8
  v_add_u32 v14, 81920, v9
  v_add_u32 v15, 81920, v10
  v_and_b32 v16, 31, v1
  v_lshlrev_b32_e64 v22, 5, v16
  s_lshl_b32 s57, s12, 11
  s_add_u32 s57, s57, 151552
  v_add_u32 v22, s57, v22
  v_and_b32 v16, 15, v1
  s_sub_u32 s57, 2, s50
  s_lshl_b32 s57, s57, 6
  v_mul_u32_u24 v18, s57, v17
  v_xor_b32 v19, s13, v17
  v_lshlrev_b32_e64 v19, 4, v19
  v_add3_u32 v18, v18, v19, v16
  v_lshlrev_b32 v18, 2, v18
  v_and_b32 v19, 31, v1
  s_lshl_b32 s57, s13, 5
  v_add_u32 v19, s57, v19
  v_lshlrev_b32_e64 v19, 2, v19
  v_add_u32 v23, 155648, v18
  v_add_u32 v24, 155776, v18
  v_add_u32 v20, 155904, v18
  v_add_u32 v21, 156160, v19
  v_cndmask_b32 v25, v20, v21, vcc
  v_add_u32 v20, 156032, v18
  v_add_u32 v21, 156416, v19
  v_cndmask_b32 v26, v20, v21, vcc
  v_add_u32 v27, 156672, v19
  s_lshl_b32 s57, s47, 2
  s_lshl_b32 s58, s12, 1
  s_add_u32 s57, s57, s58
  s_mul_i32 s70, s57, 114688
  s_lshl_b32 s59, s53, 12
  s_add_u32 s70, s70, s59
  s_lshl_b32 s59, s13, 10
  s_add_u32 s70, s70, s59
  s_add_u32 s70, s70, 8388608
  s_lshl_b32 s59, s54, 2
  s_lshl_b32 s60, s13, 1
  s_add_u32 s59, s59, s60
  s_lshl_b32 s71, s59, 6
  s_add_u32 s71, s71, s57
  s_lshl_b32 s71, s71, 10
  s_lshl_b32 s57, s57, 7
  s_lshl_b32 s72, s59, 1
  s_add_u32 s72, s72, s57
  s_lshl_b32 s72, s72, 5
  s_add_u32 s72, s72, 18350080
  s_lshl_b32 s73, s48, 3
  s_lshl_b32 s60, s13, 2
  s_add_u32 s73, s73, s60
  s_add_u32 s73, s73, s57
  s_lshl_b32 s73, s73, 5
  s_add_u32 s73, s73, 18087936
  s_add_u32 s74, s73, 4096
  s_load_dwordx2 s[24:25], s[0:1], 48
  s_load_dwordx2 s[28:29], s[0:1], 16
  s_load_dwordx2 s[36:37], s[0:1], 56
  s_waitcnt lgkmcnt(0)
  s_waitcnt vmcnt(0)
  s_barrier
  ds_read_b128 v[32:35], v2 offset:0
  ds_read_b64_tr_b16 v[40:41], v6 offset:0
  ds_read_b64_tr_b16 v[42:43], v6 offset:256
  ds_read_b128 v[36:39], v2 offset:4096
  ds_read_b64_tr_b16 v[44:45], v7 offset:0
  ds_read_b64_tr_b16 v[46:47], v7 offset:256
  ds_read_b64_tr_b16 v[48:49], v8 offset:0
  ds_read_b64_tr_b16 v[50:51], v8 offset:256
  ds_read_b64_tr_b16 v[52:53], v9 offset:0
  ds_read_b64_tr_b16 v[54:55], v9 offset:256
  ds_read_b64_tr_b16 v[56:57], v10 offset:0
  ds_read_b64_tr_b16 v[58:59], v10 offset:256
  s_waitcnt lgkmcnt(9)
  v_mfma_f32_32x32x16_bf16 v[88:103], v[40:43], v[32:35], 0
  ds_read_b128 v[60:63], v3 offset:0
  ds_read_b64_tr_b16 v[68:69], v6 offset:2048
  s_waitcnt lgkmcnt(10)
  v_mfma_f32_32x32x16_bf16 v[104:119], v[40:43], v[36:39], 0
  ds_read_b64_tr_b16 v[70:71], v6 offset:2304
  ds_read_b128 v[64:67], v3 offset:4096
  s_waitcnt lgkmcnt(10)
  v_mfma_f32_32x32x16_bf16 v[120:135], v[44:47], v[32:35], 0
  ds_read_b64_tr_b16 v[72:73], v7 offset:2048
  v_mfma_f32_32x32x16_bf16 v[136:151], v[44:47], v[36:39], 0
  ds_read_b64_tr_b16 v[74:75], v7 offset:2304
  s_waitcnt lgkmcnt(10)
  v_mfma_f32_32x32x16_bf16 v[152:167], v[48:51], v[32:35], 0
  ds_read_b64_tr_b16 v[76:77], v8 offset:2048
  v_mfma_f32_32x32x16_bf16 v[168:183], v[48:51], v[36:39], 0
  ds_read_b64_tr_b16 v[78:79], v8 offset:2304
  s_waitcnt lgkmcnt(10)
  v_mfma_f32_32x32x16_bf16 v[184:199], v[52:55], v[32:35], 0
  ds_read_b64_tr_b16 v[80:81], v9 offset:2048
  v_mfma_f32_32x32x16_bf16 v[200:215], v[52:55], v[36:39], 0
  ds_read_b64_tr_b16 v[82:83], v9 offset:2304
  s_waitcnt lgkmcnt(10)
  v_mfma_f32_32x32x16_bf16 v[216:231], v[56:59], v[32:35], 0
  ds_read_b64_tr_b16 v[84:85], v10 offset:2048
  v_mfma_f32_32x32x16_bf16 v[232:247], v[56:59], v[36:39], 0
  ds_read_b64_tr_b16 v[86:87], v10 offset:2304
  s_barrier
  s_waitcnt lgkmcnt(9)
  v_mfma_f32_32x32x16_bf16 v[88:103], v[68:71], v[60:63], v[88:103]
  ds_read_b128 v[32:35], v4 offset:0
  ds_read_b64_tr_b16 v[40:41], v6 offset:20480
  s_waitcnt lgkmcnt(10)
  v_mfma_f32_32x32x16_bf16 v[104:119], v[68:71], v[64:67], v[104:119]
  ds_read_b64_tr_b16 v[42:43], v6 offset:20736
  ds_read_b128 v[36:39], v4 offset:4096
  s_waitcnt lgkmcnt(10)
  v_mfma_f32_32x32x16_bf16 v[120:135], v[72:75], v[60:63], v[120:135]
  ds_read_b64_tr_b16 v[44:45], v7 offset:20480
  v_mfma_f32_32x32x16_bf16 v[136:151], v[72:75], v[64:67], v[136:151]
  ds_read_b64_tr_b16 v[46:47], v7 offset:20736
  s_waitcnt lgkmcnt(10)
  v_mfma_f32_32x32x16_bf16 v[152:167], v[76:79], v[60:63], v[152:167]
  ds_read_b64_tr_b16 v[48:49], v8 offset:20480
  v_mfma_f32_32x32x16_bf16 v[168:183], v[76:79], v[64:67], v[168:183]
  ds_read_b64_tr_b16 v[50:51], v8 offset:20736
  s_waitcnt lgkmcnt(10)
  v_mfma_f32_32x32x16_bf16 v[184:199], v[80:83], v[60:63], v[184:199]
  ds_read_b64_tr_b16 v[52:53], v9 offset:20480
  v_mfma_f32_32x32x16_bf16 v[200:215], v[80:83], v[64:67], v[200:215]
  ds_read_b64_tr_b16 v[54:55], v9 offset:20736
  s_waitcnt lgkmcnt(10)
  v_mfma_f32_32x32x16_bf16 v[216:231], v[84:87], v[60:63], v[216:231]
  ds_read_b64_tr_b16 v[56:57], v10 offset:20480
  v_mfma_f32_32x32x16_bf16 v[232:247], v[84:87], v[64:67], v[232:247]
  ds_read_b64_tr_b16 v[58:59], v10 offset:20736
  s_waitcnt lgkmcnt(9)
  v_mfma_f32_32x32x16_bf16 v[88:103], v[40:43], v[32:35], v[88:103]
  ds_read_b128 v[60:63], v5 offset:0
  ds_read_b64_tr_b16 v[68:69], v6 offset:22528
  s_waitcnt lgkmcnt(10)
  v_mfma_f32_32x32x16_bf16 v[104:119], v[40:43], v[36:39], v[104:119]
  ds_read_b64_tr_b16 v[70:71], v6 offset:22784
  ds_read_b128 v[64:67], v5 offset:4096
  s_waitcnt lgkmcnt(10)
  v_mfma_f32_32x32x16_bf16 v[120:135], v[44:47], v[32:35], v[120:135]
  ds_read_b64_tr_b16 v[72:73], v7 offset:22528
  v_mfma_f32_32x32x16_bf16 v[136:151], v[44:47], v[36:39], v[136:151]
  ds_read_b64_tr_b16 v[74:75], v7 offset:22784
  s_waitcnt lgkmcnt(10)
  v_mfma_f32_32x32x16_bf16 v[152:167], v[48:51], v[32:35], v[152:167]
  ds_read_b64_tr_b16 v[76:77], v8 offset:22528
  v_mfma_f32_32x32x16_bf16 v[168:183], v[48:51], v[36:39], v[168:183]
  ds_read_b64_tr_b16 v[78:79], v8 offset:22784
  s_waitcnt lgkmcnt(10)
  v_mfma_f32_32x32x16_bf16 v[184:199], v[52:55], v[32:35], v[184:199]
  ds_read_b64_tr_b16 v[80:81], v9 offset:22528
  v_mfma_f32_32x32x16_bf16 v[200:215], v[52:55], v[36:39], v[200:215]
  ds_read_b64_tr_b16 v[82:83], v9 offset:22784
  s_waitcnt lgkmcnt(10)
  v_mfma_f32_32x32x16_bf16 v[216:231], v[56:59], v[32:35], v[216:231]
  ds_read_b64_tr_b16 v[84:85], v10 offset:22528
  v_mfma_f32_32x32x16_bf16 v[232:247], v[56:59], v[36:39], v[232:247]
  ds_read_b64_tr_b16 v[86:87], v10 offset:22784
  s_barrier
  s_waitcnt lgkmcnt(9)
  v_mfma_f32_32x32x16_bf16 v[88:103], v[68:71], v[60:63], v[88:103]
  ds_read_b128 v[32:35], v2 offset:16384
  ds_read_b64_tr_b16 v[40:41], v6 offset:40960
  s_waitcnt lgkmcnt(10)
  v_mfma_f32_32x32x16_bf16 v[104:119], v[68:71], v[64:67], v[104:119]
  ds_read_b64_tr_b16 v[42:43], v6 offset:41216
  ds_read_b128 v[36:39], v2 offset:20480
  s_waitcnt lgkmcnt(10)
  v_mfma_f32_32x32x16_bf16 v[120:135], v[72:75], v[60:63], v[120:135]
  ds_read_b64_tr_b16 v[44:45], v7 offset:40960
  v_mfma_f32_32x32x16_bf16 v[136:151], v[72:75], v[64:67], v[136:151]
  ds_read_b64_tr_b16 v[46:47], v7 offset:41216
  s_waitcnt lgkmcnt(10)
  v_mfma_f32_32x32x16_bf16 v[152:167], v[76:79], v[60:63], v[152:167]
  ds_read_b64_tr_b16 v[48:49], v8 offset:40960
  v_mfma_f32_32x32x16_bf16 v[168:183], v[76:79], v[64:67], v[168:183]
  ds_read_b64_tr_b16 v[50:51], v8 offset:41216
  s_waitcnt lgkmcnt(10)
  v_mfma_f32_32x32x16_bf16 v[184:199], v[80:83], v[60:63], v[184:199]
  ds_read_b64_tr_b16 v[52:53], v9 offset:40960
  v_mfma_f32_32x32x16_bf16 v[200:215], v[80:83], v[64:67], v[200:215]
  ds_read_b64_tr_b16 v[54:55], v9 offset:41216
  s_waitcnt lgkmcnt(10)
  v_mfma_f32_32x32x16_bf16 v[216:231], v[84:87], v[60:63], v[216:231]
  ds_read_b64_tr_b16 v[56:57], v10 offset:40960
  v_mfma_f32_32x32x16_bf16 v[232:247], v[84:87], v[64:67], v[232:247]
  ds_read_b64_tr_b16 v[58:59], v10 offset:41216
  s_waitcnt lgkmcnt(9)
  v_mfma_f32_32x32x16_bf16 v[88:103], v[40:43], v[32:35], v[88:103]
  ds_read_b128 v[60:63], v3 offset:16384
  ds_read_b64_tr_b16 v[68:69], v6 offset:43008
  s_waitcnt lgkmcnt(10)
  v_mfma_f32_32x32x16_bf16 v[104:119], v[40:43], v[36:39], v[104:119]
  ds_read_b64_tr_b16 v[70:71], v6 offset:43264
  ds_read_b128 v[64:67], v3 offset:20480
  s_waitcnt lgkmcnt(10)
  v_mfma_f32_32x32x16_bf16 v[120:135], v[44:47], v[32:35], v[120:135]
  ds_read_b64_tr_b16 v[72:73], v7 offset:43008
  v_mfma_f32_32x32x16_bf16 v[136:151], v[44:47], v[36:39], v[136:151]
  ds_read_b64_tr_b16 v[74:75], v7 offset:43264
  s_waitcnt lgkmcnt(10)
  v_mfma_f32_32x32x16_bf16 v[152:167], v[48:51], v[32:35], v[152:167]
  ds_read_b64_tr_b16 v[76:77], v8 offset:43008
  v_mfma_f32_32x32x16_bf16 v[168:183], v[48:51], v[36:39], v[168:183]
  ds_read_b64_tr_b16 v[78:79], v8 offset:43264
  s_waitcnt lgkmcnt(10)
  v_mfma_f32_32x32x16_bf16 v[184:199], v[52:55], v[32:35], v[184:199]
  ds_read_b64_tr_b16 v[80:81], v9 offset:43008
  v_mfma_f32_32x32x16_bf16 v[200:215], v[52:55], v[36:39], v[200:215]
  ds_read_b64_tr_b16 v[82:83], v9 offset:43264
  s_waitcnt lgkmcnt(10)
  v_mfma_f32_32x32x16_bf16 v[216:231], v[56:59], v[32:35], v[216:231]
  ds_read_b64_tr_b16 v[84:85], v10 offset:43008
  v_mfma_f32_32x32x16_bf16 v[232:247], v[56:59], v[36:39], v[232:247]
  ds_read_b64_tr_b16 v[86:87], v10 offset:43264
  s_barrier
  s_waitcnt lgkmcnt(9)
  v_mfma_f32_32x32x16_bf16 v[88:103], v[68:71], v[60:63], v[88:103]
  ds_read_b128 v[32:35], v4 offset:16384
  ds_read_b64_tr_b16 v[40:41], v6 offset:61440
  s_waitcnt lgkmcnt(10)
  v_mfma_f32_32x32x16_bf16 v[104:119], v[68:71], v[64:67], v[104:119]
  ds_read_b64_tr_b16 v[42:43], v6 offset:61696
  ds_read_b128 v[36:39], v4 offset:20480
  s_waitcnt lgkmcnt(10)
  v_mfma_f32_32x32x16_bf16 v[120:135], v[72:75], v[60:63], v[120:135]
  ds_read_b64_tr_b16 v[44:45], v7 offset:61440
  v_mfma_f32_32x32x16_bf16 v[136:151], v[72:75], v[64:67], v[136:151]
  ds_read_b64_tr_b16 v[46:47], v7 offset:61696
  s_waitcnt lgkmcnt(10)
  v_mfma_f32_32x32x16_bf16 v[152:167], v[76:79], v[60:63], v[152:167]
  ds_read_b64_tr_b16 v[48:49], v8 offset:61440
  v_mfma_f32_32x32x16_bf16 v[168:183], v[76:79], v[64:67], v[168:183]
  ds_read_b64_tr_b16 v[50:51], v8 offset:61696
  s_waitcnt lgkmcnt(10)
  v_mfma_f32_32x32x16_bf16 v[184:199], v[80:83], v[60:63], v[184:199]
  ds_read_b64_tr_b16 v[52:53], v9 offset:61440
  v_mfma_f32_32x32x16_bf16 v[200:215], v[80:83], v[64:67], v[200:215]
  ds_read_b64_tr_b16 v[54:55], v9 offset:61696
  s_waitcnt lgkmcnt(10)
  v_mfma_f32_32x32x16_bf16 v[216:231], v[84:87], v[60:63], v[216:231]
  ds_read_b64_tr_b16 v[56:57], v10 offset:61440
  v_mfma_f32_32x32x16_bf16 v[232:247], v[84:87], v[64:67], v[232:247]
  ds_read_b64_tr_b16 v[58:59], v10 offset:61696
  s_waitcnt lgkmcnt(9)
  v_mfma_f32_32x32x16_bf16 v[88:103], v[40:43], v[32:35], v[88:103]
  ds_read_b128 v[60:63], v5 offset:16384
  ds_read_b64_tr_b16 v[68:69], v6 offset:63488
  s_waitcnt lgkmcnt(10)
  v_mfma_f32_32x32x16_bf16 v[104:119], v[40:43], v[36:39], v[104:119]
  ds_read_b64_tr_b16 v[70:71], v6 offset:63744
  ds_read_b128 v[64:67], v5 offset:20480
  s_waitcnt lgkmcnt(10)
  v_mfma_f32_32x32x16_bf16 v[120:135], v[44:47], v[32:35], v[120:135]
  ds_read_b64_tr_b16 v[72:73], v7 offset:63488
  v_mfma_f32_32x32x16_bf16 v[136:151], v[44:47], v[36:39], v[136:151]
  ds_read_b64_tr_b16 v[74:75], v7 offset:63744
  s_waitcnt lgkmcnt(10)
  v_mfma_f32_32x32x16_bf16 v[152:167], v[48:51], v[32:35], v[152:167]
  ds_read_b64_tr_b16 v[76:77], v8 offset:63488
  v_mfma_f32_32x32x16_bf16 v[168:183], v[48:51], v[36:39], v[168:183]
  ds_read_b64_tr_b16 v[78:79], v8 offset:63744
  s_waitcnt lgkmcnt(10)
  v_mfma_f32_32x32x16_bf16 v[184:199], v[52:55], v[32:35], v[184:199]
  ds_read_b64_tr_b16 v[80:81], v9 offset:63488
  v_mfma_f32_32x32x16_bf16 v[200:215], v[52:55], v[36:39], v[200:215]
  ds_read_b64_tr_b16 v[82:83], v9 offset:63744
  s_waitcnt lgkmcnt(10)
  v_mfma_f32_32x32x16_bf16 v[216:231], v[56:59], v[32:35], v[216:231]
  ds_read_b64_tr_b16 v[84:85], v10 offset:63488
  v_mfma_f32_32x32x16_bf16 v[232:247], v[56:59], v[36:39], v[232:247]
  ds_read_b64_tr_b16 v[86:87], v10 offset:63744
  s_barrier
  s_waitcnt lgkmcnt(9)
  v_mfma_f32_32x32x16_bf16 v[88:103], v[68:71], v[60:63], v[88:103]
  ds_read_b128 v[32:35], v2 offset:32768
  ds_read_b64_tr_b16 v[40:41], v11 offset:0
  s_waitcnt lgkmcnt(10)
  v_mfma_f32_32x32x16_bf16 v[104:119], v[68:71], v[64:67], v[104:119]
  ds_read_b64_tr_b16 v[42:43], v11 offset:256
  ds_read_b128 v[36:39], v2 offset:36864
  s_waitcnt lgkmcnt(10)
  v_mfma_f32_32x32x16_bf16 v[120:135], v[72:75], v[60:63], v[120:135]
  ds_read_b64_tr_b16 v[44:45], v12 offset:0
  v_mfma_f32_32x32x16_bf16 v[136:151], v[72:75], v[64:67], v[136:151]
  ds_read_b64_tr_b16 v[46:47], v12 offset:256
  s_waitcnt lgkmcnt(10)
  v_mfma_f32_32x32x16_bf16 v[152:167], v[76:79], v[60:63], v[152:167]
  ds_read_b64_tr_b16 v[48:49], v13 offset:0
  v_mfma_f32_32x32x16_bf16 v[168:183], v[76:79], v[64:67], v[168:183]
  ds_read_b64_tr_b16 v[50:51], v13 offset:256
  s_waitcnt lgkmcnt(10)
  v_mfma_f32_32x32x16_bf16 v[184:199], v[80:83], v[60:63], v[184:199]
  ds_read_b64_tr_b16 v[52:53], v14 offset:0
  v_mfma_f32_32x32x16_bf16 v[200:215], v[80:83], v[64:67], v[200:215]
  ds_read_b64_tr_b16 v[54:55], v14 offset:256
  s_waitcnt lgkmcnt(10)
  v_mfma_f32_32x32x16_bf16 v[216:231], v[84:87], v[60:63], v[216:231]
  ds_read_b64_tr_b16 v[56:57], v15 offset:0
  v_mfma_f32_32x32x16_bf16 v[232:247], v[84:87], v[64:67], v[232:247]
  ds_read_b64_tr_b16 v[58:59], v15 offset:256
  s_waitcnt lgkmcnt(9)
  v_mfma_f32_32x32x16_bf16 v[88:103], v[40:43], v[32:35], v[88:103]
  ds_read_b128 v[60:63], v3 offset:32768
  ds_read_b64_tr_b16 v[68:69], v11 offset:2048
  s_waitcnt lgkmcnt(10)
  v_mfma_f32_32x32x16_bf16 v[104:119], v[40:43], v[36:39], v[104:119]
  ds_read_b64_tr_b16 v[70:71], v11 offset:2304
  ds_read_b128 v[64:67], v3 offset:36864
  s_waitcnt lgkmcnt(10)
  v_mfma_f32_32x32x16_bf16 v[120:135], v[44:47], v[32:35], v[120:135]
  ds_read_b64_tr_b16 v[72:73], v12 offset:2048
  v_mfma_f32_32x32x16_bf16 v[136:151], v[44:47], v[36:39], v[136:151]
  ds_read_b64_tr_b16 v[74:75], v12 offset:2304
  s_waitcnt lgkmcnt(10)
  v_mfma_f32_32x32x16_bf16 v[152:167], v[48:51], v[32:35], v[152:167]
  ds_read_b64_tr_b16 v[76:77], v13 offset:2048
  v_mfma_f32_32x32x16_bf16 v[168:183], v[48:51], v[36:39], v[168:183]
  ds_read_b64_tr_b16 v[78:79], v13 offset:2304
  s_waitcnt lgkmcnt(10)
  v_mfma_f32_32x32x16_bf16 v[184:199], v[52:55], v[32:35], v[184:199]
  ds_read_b64_tr_b16 v[80:81], v14 offset:2048
  v_mfma_f32_32x32x16_bf16 v[200:215], v[52:55], v[36:39], v[200:215]
  ds_read_b64_tr_b16 v[82:83], v14 offset:2304
  s_waitcnt lgkmcnt(10)
  v_mfma_f32_32x32x16_bf16 v[216:231], v[56:59], v[32:35], v[216:231]
  ds_read_b64_tr_b16 v[84:85], v15 offset:2048
  v_mfma_f32_32x32x16_bf16 v[232:247], v[56:59], v[36:39], v[232:247]
  ds_read_b64_tr_b16 v[86:87], v15 offset:2304
  s_barrier
  s_waitcnt lgkmcnt(9)
  v_mfma_f32_32x32x16_bf16 v[88:103], v[68:71], v[60:63], v[88:103]
  ds_read_b128 v[32:35], v4 offset:32768
  ds_read_b64_tr_b16 v[40:41], v6 offset:0
  s_waitcnt lgkmcnt(10)
  v_mfma_f32_32x32x16_bf16 v[104:119], v[68:71], v[64:67], v[104:119]
  ds_read_b64_tr_b16 v[42:43], v6 offset:256
  ds_read_b128 v[36:39], v4 offset:36864
  s_waitcnt lgkmcnt(10)
  v_mfma_f32_32x32x16_bf16 v[120:135], v[72:75], v[60:63], v[120:135]
  ds_read_b64_tr_b16 v[44:45], v7 offset:0
  v_mfma_f32_32x32x16_bf16 v[136:151], v[72:75], v[64:67], v[136:151]
  ds_read_b64_tr_b16 v[46:47], v7 offset:256
  s_waitcnt lgkmcnt(10)
  v_mfma_f32_32x32x16_bf16 v[152:167], v[76:79], v[60:63], v[152:167]
  ds_read_b64_tr_b16 v[48:49], v8 offset:0
  v_mfma_f32_32x32x16_bf16 v[168:183], v[76:79], v[64:67], v[168:183]
  ds_read_b64_tr_b16 v[50:51], v8 offset:256
  s_waitcnt lgkmcnt(10)
  v_mfma_f32_32x32x16_bf16 v[184:199], v[80:83], v[60:63], v[184:199]
  ds_read_b64_tr_b16 v[52:53], v9 offset:0
  v_mfma_f32_32x32x16_bf16 v[200:215], v[80:83], v[64:67], v[200:215]
  ds_read_b64_tr_b16 v[54:55], v9 offset:256
  s_waitcnt lgkmcnt(10)
  v_mfma_f32_32x32x16_bf16 v[216:231], v[84:87], v[60:63], v[216:231]
  ds_read_b64_tr_b16 v[56:57], v10 offset:0
  v_mfma_f32_32x32x16_bf16 v[232:247], v[84:87], v[64:67], v[232:247]
  ds_read_b64_tr_b16 v[58:59], v10 offset:256
  s_waitcnt lgkmcnt(9)
  v_mfma_f32_32x32x16_bf16 v[88:103], v[40:43], v[32:35], v[88:103]
  ds_read_b128 v[60:63], v5 offset:32768
  ds_read_b64_tr_b16 v[68:69], v6 offset:2048
  s_waitcnt lgkmcnt(10)
  v_mfma_f32_32x32x16_bf16 v[104:119], v[40:43], v[36:39], v[104:119]
  ds_read_b64_tr_b16 v[70:71], v6 offset:2304
  ds_read_b128 v[64:67], v5 offset:36864
  s_waitcnt lgkmcnt(10)
  v_mfma_f32_32x32x16_bf16 v[120:135], v[44:47], v[32:35], v[120:135]
  ds_read_b64_tr_b16 v[72:73], v7 offset:2048
  v_mfma_f32_32x32x16_bf16 v[136:151], v[44:47], v[36:39], v[136:151]
  ds_read_b64_tr_b16 v[74:75], v7 offset:2304
  s_waitcnt lgkmcnt(10)
  v_mfma_f32_32x32x16_bf16 v[152:167], v[48:51], v[32:35], v[152:167]
  ds_read_b64_tr_b16 v[76:77], v8 offset:2048
  v_mfma_f32_32x32x16_bf16 v[168:183], v[48:51], v[36:39], v[168:183]
  ds_read_b64_tr_b16 v[78:79], v8 offset:2304
  s_waitcnt lgkmcnt(10)
  v_mfma_f32_32x32x16_bf16 v[184:199], v[52:55], v[32:35], v[184:199]
  ds_read_b64_tr_b16 v[80:81], v9 offset:2048
  v_mfma_f32_32x32x16_bf16 v[200:215], v[52:55], v[36:39], v[200:215]
  ds_read_b64_tr_b16 v[82:83], v9 offset:2304
  s_waitcnt lgkmcnt(10)
  v_mfma_f32_32x32x16_bf16 v[216:231], v[56:59], v[32:35], v[216:231]
  ds_read_b64_tr_b16 v[84:85], v10 offset:2048
  v_mfma_f32_32x32x16_bf16 v[232:247], v[56:59], v[36:39], v[232:247]
  ds_read_b64_tr_b16 v[86:87], v10 offset:2304
  s_barrier
  s_waitcnt lgkmcnt(9)
  v_mfma_f32_32x32x16_bf16 v[88:103], v[68:71], v[60:63], v[88:103]
  ds_read_b128 v[32:35], v2 offset:0
  ds_read_b64_tr_b16 v[40:41], v6 offset:20480
  s_waitcnt lgkmcnt(10)
  v_mfma_f32_32x32x16_bf16 v[104:119], v[68:71], v[64:67], v[104:119]
  ds_read_b64_tr_b16 v[42:43], v6 offset:20736
  ds_read_b128 v[36:39], v2 offset:4096
  s_waitcnt lgkmcnt(10)
  v_mfma_f32_32x32x16_bf16 v[120:135], v[72:75], v[60:63], v[120:135]
  ds_read_b64_tr_b16 v[44:45], v7 offset:20480
  v_mfma_f32_32x32x16_bf16 v[136:151], v[72:75], v[64:67], v[136:151]
  ds_read_b64_tr_b16 v[46:47], v7 offset:20736
  s_waitcnt lgkmcnt(10)
  v_mfma_f32_32x32x16_bf16 v[152:167], v[76:79], v[60:63], v[152:167]
  ds_read_b64_tr_b16 v[48:49], v8 offset:20480
  v_mfma_f32_32x32x16_bf16 v[168:183], v[76:79], v[64:67], v[168:183]
  ds_read_b64_tr_b16 v[50:51], v8 offset:20736
  s_waitcnt lgkmcnt(10)
  v_mfma_f32_32x32x16_bf16 v[184:199], v[80:83], v[60:63], v[184:199]
  ds_read_b64_tr_b16 v[52:53], v9 offset:20480
  v_mfma_f32_32x32x16_bf16 v[200:215], v[80:83], v[64:67], v[200:215]
  ds_read_b64_tr_b16 v[54:55], v9 offset:20736
  s_waitcnt lgkmcnt(10)
  v_mfma_f32_32x32x16_bf16 v[216:231], v[84:87], v[60:63], v[216:231]
  ds_read_b64_tr_b16 v[56:57], v10 offset:20480
  v_mfma_f32_32x32x16_bf16 v[232:247], v[84:87], v[64:67], v[232:247]
  ds_read_b64_tr_b16 v[58:59], v10 offset:20736
  s_waitcnt lgkmcnt(9)
  v_mfma_f32_32x32x16_bf16 v[88:103], v[40:43], v[32:35], v[88:103]
  ds_read_b128 v[60:63], v3 offset:0
  ds_read_b64_tr_b16 v[68:69], v6 offset:22528
  s_waitcnt lgkmcnt(10)
  v_mfma_f32_32x32x16_bf16 v[104:119], v[40:43], v[36:39], v[104:119]
  ds_read_b64_tr_b16 v[70:71], v6 offset:22784
  ds_read_b128 v[64:67], v3 offset:4096
  s_waitcnt lgkmcnt(10)
  v_mfma_f32_32x32x16_bf16 v[120:135], v[44:47], v[32:35], v[120:135]
  ds_read_b64_tr_b16 v[72:73], v7 offset:22528
  v_mfma_f32_32x32x16_bf16 v[136:151], v[44:47], v[36:39], v[136:151]
  ds_read_b64_tr_b16 v[74:75], v7 offset:22784
  s_waitcnt lgkmcnt(10)
  v_mfma_f32_32x32x16_bf16 v[152:167], v[48:51], v[32:35], v[152:167]
  ds_read_b64_tr_b16 v[76:77], v8 offset:22528
  v_mfma_f32_32x32x16_bf16 v[168:183], v[48:51], v[36:39], v[168:183]
  ds_read_b64_tr_b16 v[78:79], v8 offset:22784
  s_waitcnt lgkmcnt(10)
  v_mfma_f32_32x32x16_bf16 v[184:199], v[52:55], v[32:35], v[184:199]
  ds_read_b64_tr_b16 v[80:81], v9 offset:22528
  v_mfma_f32_32x32x16_bf16 v[200:215], v[52:55], v[36:39], v[200:215]
  ds_read_b64_tr_b16 v[82:83], v9 offset:22784
  s_waitcnt lgkmcnt(10)
  v_mfma_f32_32x32x16_bf16 v[216:231], v[56:59], v[32:35], v[216:231]
  ds_read_b64_tr_b16 v[84:85], v10 offset:22528
  v_mfma_f32_32x32x16_bf16 v[232:247], v[56:59], v[36:39], v[232:247]
  ds_read_b64_tr_b16 v[86:87], v10 offset:22784
  s_barrier
  s_waitcnt lgkmcnt(9)
  v_mfma_f32_32x32x16_bf16 v[88:103], v[68:71], v[60:63], v[88:103]
  ds_read_b128 v[32:35], v4 offset:0
  ds_read_b64_tr_b16 v[40:41], v6 offset:40960
  s_waitcnt lgkmcnt(10)
  v_mfma_f32_32x32x16_bf16 v[104:119], v[68:71], v[64:67], v[104:119]
  ds_read_b64_tr_b16 v[42:43], v6 offset:41216
  ds_read_b128 v[36:39], v4 offset:4096
  s_waitcnt lgkmcnt(10)
  v_mfma_f32_32x32x16_bf16 v[120:135], v[72:75], v[60:63], v[120:135]
  ds_read_b64_tr_b16 v[44:45], v7 offset:40960
  v_mfma_f32_32x32x16_bf16 v[136:151], v[72:75], v[64:67], v[136:151]
  ds_read_b64_tr_b16 v[46:47], v7 offset:41216
  s_waitcnt lgkmcnt(10)
  v_mfma_f32_32x32x16_bf16 v[152:167], v[76:79], v[60:63], v[152:167]
  ds_read_b64_tr_b16 v[48:49], v8 offset:40960
  v_mfma_f32_32x32x16_bf16 v[168:183], v[76:79], v[64:67], v[168:183]
  ds_read_b64_tr_b16 v[50:51], v8 offset:41216
  s_waitcnt lgkmcnt(10)
  v_mfma_f32_32x32x16_bf16 v[184:199], v[80:83], v[60:63], v[184:199]
  ds_read_b64_tr_b16 v[52:53], v9 offset:40960
  v_mfma_f32_32x32x16_bf16 v[200:215], v[80:83], v[64:67], v[200:215]
  ds_read_b64_tr_b16 v[54:55], v9 offset:41216
  s_waitcnt lgkmcnt(10)
  v_mfma_f32_32x32x16_bf16 v[216:231], v[84:87], v[60:63], v[216:231]
  ds_read_b64_tr_b16 v[56:57], v10 offset:40960
  v_mfma_f32_32x32x16_bf16 v[232:247], v[84:87], v[64:67], v[232:247]
  ds_read_b64_tr_b16 v[58:59], v10 offset:41216
  s_waitcnt lgkmcnt(9)
  v_mfma_f32_32x32x16_bf16 v[88:103], v[40:43], v[32:35], v[88:103]
  ds_read_b128 v[60:63], v5 offset:0
  ds_read_b64_tr_b16 v[68:69], v6 offset:43008
  s_waitcnt lgkmcnt(10)
  v_mfma_f32_32x32x16_bf16 v[104:119], v[40:43], v[36:39], v[104:119]
  ds_read_b64_tr_b16 v[70:71], v6 offset:43264
  ds_read_b128 v[64:67], v5 offset:4096
  s_waitcnt lgkmcnt(10)
  v_mfma_f32_32x32x16_bf16 v[120:135], v[44:47], v[32:35], v[120:135]
  ds_read_b64_tr_b16 v[72:73], v7 offset:43008
  v_mfma_f32_32x32x16_bf16 v[136:151], v[44:47], v[36:39], v[136:151]
  ds_read_b64_tr_b16 v[74:75], v7 offset:43264
  s_waitcnt lgkmcnt(10)
  v_mfma_f32_32x32x16_bf16 v[152:167], v[48:51], v[32:35], v[152:167]
  ds_read_b64_tr_b16 v[76:77], v8 offset:43008
  v_mfma_f32_32x32x16_bf16 v[168:183], v[48:51], v[36:39], v[168:183]
  ds_read_b64_tr_b16 v[78:79], v8 offset:43264
  s_waitcnt lgkmcnt(10)
  v_mfma_f32_32x32x16_bf16 v[184:199], v[52:55], v[32:35], v[184:199]
  ds_read_b64_tr_b16 v[80:81], v9 offset:43008
  v_mfma_f32_32x32x16_bf16 v[200:215], v[52:55], v[36:39], v[200:215]
  ds_read_b64_tr_b16 v[82:83], v9 offset:43264
  s_waitcnt lgkmcnt(10)
  v_mfma_f32_32x32x16_bf16 v[216:231], v[56:59], v[32:35], v[216:231]
  ds_read_b64_tr_b16 v[84:85], v10 offset:43008
  v_mfma_f32_32x32x16_bf16 v[232:247], v[56:59], v[36:39], v[232:247]
  ds_read_b64_tr_b16 v[86:87], v10 offset:43264
  s_barrier
  s_waitcnt lgkmcnt(9)
  v_mfma_f32_32x32x16_bf16 v[88:103], v[68:71], v[60:63], v[88:103]
  ds_read_b128 v[32:35], v2 offset:16384
  ds_read_b64_tr_b16 v[40:41], v6 offset:61440
  s_waitcnt lgkmcnt(10)
  v_mfma_f32_32x32x16_bf16 v[104:119], v[68:71], v[64:67], v[104:119]
  ds_read_b64_tr_b16 v[42:43], v6 offset:61696
  ds_read_b128 v[36:39], v2 offset:20480
  s_waitcnt lgkmcnt(10)
  v_mfma_f32_32x32x16_bf16 v[120:135], v[72:75], v[60:63], v[120:135]
  ds_read_b64_tr_b16 v[44:45], v7 offset:61440
  v_mfma_f32_32x32x16_bf16 v[136:151], v[72:75], v[64:67], v[136:151]
  ds_read_b64_tr_b16 v[46:47], v7 offset:61696
  s_waitcnt lgkmcnt(10)
  v_mfma_f32_32x32x16_bf16 v[152:167], v[76:79], v[60:63], v[152:167]
  ds_read_b64_tr_b16 v[48:49], v8 offset:61440
  v_mfma_f32_32x32x16_bf16 v[168:183], v[76:79], v[64:67], v[168:183]
  ds_read_b64_tr_b16 v[50:51], v8 offset:61696
  s_waitcnt lgkmcnt(10)
  v_mfma_f32_32x32x16_bf16 v[184:199], v[80:83], v[60:63], v[184:199]
  ds_read_b64_tr_b16 v[52:53], v9 offset:61440
  v_mfma_f32_32x32x16_bf16 v[200:215], v[80:83], v[64:67], v[200:215]
  ds_read_b64_tr_b16 v[54:55], v9 offset:61696
  s_waitcnt lgkmcnt(10)
  v_mfma_f32_32x32x16_bf16 v[216:231], v[84:87], v[60:63], v[216:231]
  ds_read_b64_tr_b16 v[56:57], v10 offset:61440
  v_mfma_f32_32x32x16_bf16 v[232:247], v[84:87], v[64:67], v[232:247]
  ds_read_b64_tr_b16 v[58:59], v10 offset:61696
  s_waitcnt lgkmcnt(9)
  v_mfma_f32_32x32x16_bf16 v[88:103], v[40:43], v[32:35], v[88:103]
  ds_read_b128 v[60:63], v3 offset:16384
  ds_read_b64_tr_b16 v[68:69], v6 offset:63488
  s_waitcnt lgkmcnt(10)
  v_mfma_f32_32x32x16_bf16 v[104:119], v[40:43], v[36:39], v[104:119]
  ds_read_b64_tr_b16 v[70:71], v6 offset:63744
  ds_read_b128 v[64:67], v3 offset:20480
  s_waitcnt lgkmcnt(10)
  v_mfma_f32_32x32x16_bf16 v[120:135], v[44:47], v[32:35], v[120:135]
  ds_read_b64_tr_b16 v[72:73], v7 offset:63488
  v_mfma_f32_32x32x16_bf16 v[136:151], v[44:47], v[36:39], v[136:151]
  ds_read_b64_tr_b16 v[74:75], v7 offset:63744
  s_waitcnt lgkmcnt(10)
  v_mfma_f32_32x32x16_bf16 v[152:167], v[48:51], v[32:35], v[152:167]
  ds_read_b64_tr_b16 v[76:77], v8 offset:63488
  v_mfma_f32_32x32x16_bf16 v[168:183], v[48:51], v[36:39], v[168:183]
  ds_read_b64_tr_b16 v[78:79], v8 offset:63744
  s_waitcnt lgkmcnt(10)
  v_mfma_f32_32x32x16_bf16 v[184:199], v[52:55], v[32:35], v[184:199]
  ds_read_b64_tr_b16 v[80:81], v9 offset:63488
  v_mfma_f32_32x32x16_bf16 v[200:215], v[52:55], v[36:39], v[200:215]
  ds_read_b64_tr_b16 v[82:83], v9 offset:63744
  s_waitcnt lgkmcnt(10)
  v_mfma_f32_32x32x16_bf16 v[216:231], v[56:59], v[32:35], v[216:231]
  ds_read_b64_tr_b16 v[84:85], v10 offset:63488
  v_mfma_f32_32x32x16_bf16 v[232:247], v[56:59], v[36:39], v[232:247]
  ds_read_b64_tr_b16 v[86:87], v10 offset:63744
  s_barrier
  s_waitcnt lgkmcnt(9)
  v_mfma_f32_32x32x16_bf16 v[88:103], v[68:71], v[60:63], v[88:103]
  ds_read_b128 v[32:35], v4 offset:16384
  ds_read_b64_tr_b16 v[40:41], v11 offset:0
  s_waitcnt lgkmcnt(10)
  v_mfma_f32_32x32x16_bf16 v[104:119], v[68:71], v[64:67], v[104:119]
  ds_read_b64_tr_b16 v[42:43], v11 offset:256
  ds_read_b128 v[36:39], v4 offset:20480
  s_waitcnt lgkmcnt(10)
  v_mfma_f32_32x32x16_bf16 v[120:135], v[72:75], v[60:63], v[120:135]
  ds_read_b64_tr_b16 v[44:45], v12 offset:0
  v_mfma_f32_32x32x16_bf16 v[136:151], v[72:75], v[64:67], v[136:151]
  ds_read_b64_tr_b16 v[46:47], v12 offset:256
  s_waitcnt lgkmcnt(10)
  v_mfma_f32_32x32x16_bf16 v[152:167], v[76:79], v[60:63], v[152:167]
  ds_read_b64_tr_b16 v[48:49], v13 offset:0
  v_mfma_f32_32x32x16_bf16 v[168:183], v[76:79], v[64:67], v[168:183]
  ds_read_b64_tr_b16 v[50:51], v13 offset:256
  s_waitcnt lgkmcnt(10)
  v_mfma_f32_32x32x16_bf16 v[184:199], v[80:83], v[60:63], v[184:199]
  ds_read_b64_tr_b16 v[52:53], v14 offset:0
  v_mfma_f32_32x32x16_bf16 v[200:215], v[80:83], v[64:67], v[200:215]
  ds_read_b64_tr_b16 v[54:55], v14 offset:256
  s_waitcnt lgkmcnt(10)
  v_mfma_f32_32x32x16_bf16 v[216:231], v[84:87], v[60:63], v[216:231]
  ds_read_b64_tr_b16 v[56:57], v15 offset:0
  v_mfma_f32_32x32x16_bf16 v[232:247], v[84:87], v[64:67], v[232:247]
  ds_read_b64_tr_b16 v[58:59], v15 offset:256
  s_waitcnt lgkmcnt(9)
  v_mfma_f32_32x32x16_bf16 v[88:103], v[40:43], v[32:35], v[88:103]
  ds_read_b128 v[60:63], v5 offset:16384
  ds_read_b64_tr_b16 v[68:69], v11 offset:2048
  s_waitcnt lgkmcnt(10)
  v_mfma_f32_32x32x16_bf16 v[104:119], v[40:43], v[36:39], v[104:119]
  ds_read_b64_tr_b16 v[70:71], v11 offset:2304
  ds_read_b128 v[64:67], v5 offset:20480
  s_waitcnt lgkmcnt(10)
  v_mfma_f32_32x32x16_bf16 v[120:135], v[44:47], v[32:35], v[120:135]
  ds_read_b64_tr_b16 v[72:73], v12 offset:2048
  v_mfma_f32_32x32x16_bf16 v[136:151], v[44:47], v[36:39], v[136:151]
  ds_read_b64_tr_b16 v[74:75], v12 offset:2304
  s_waitcnt lgkmcnt(10)
  v_mfma_f32_32x32x16_bf16 v[152:167], v[48:51], v[32:35], v[152:167]
  ds_read_b64_tr_b16 v[76:77], v13 offset:2048
  v_mfma_f32_32x32x16_bf16 v[168:183], v[48:51], v[36:39], v[168:183]
  ds_read_b64_tr_b16 v[78:79], v13 offset:2304
  s_waitcnt lgkmcnt(10)
  v_mfma_f32_32x32x16_bf16 v[184:199], v[52:55], v[32:35], v[184:199]
  ds_read_b64_tr_b16 v[80:81], v14 offset:2048
  v_mfma_f32_32x32x16_bf16 v[200:215], v[52:55], v[36:39], v[200:215]
  ds_read_b64_tr_b16 v[82:83], v14 offset:2304
  s_waitcnt lgkmcnt(10)
  v_mfma_f32_32x32x16_bf16 v[216:231], v[56:59], v[32:35], v[216:231]
  ds_read_b64_tr_b16 v[84:85], v15 offset:2048
  v_mfma_f32_32x32x16_bf16 v[232:247], v[56:59], v[36:39], v[232:247]
  ds_read_b64_tr_b16 v[86:87], v15 offset:2304
  s_barrier
  s_waitcnt lgkmcnt(9)
  v_mfma_f32_32x32x16_bf16 v[88:103], v[68:71], v[60:63], v[88:103]
  ds_read_b128 v[32:35], v2 offset:32768
  ds_read_b64_tr_b16 v[40:41], v6 offset:0
  s_waitcnt lgkmcnt(10)
  v_mfma_f32_32x32x16_bf16 v[104:119], v[68:71], v[64:67], v[104:119]
  ds_read_b64_tr_b16 v[42:43], v6 offset:256
  ds_read_b128 v[36:39], v2 offset:36864
  s_waitcnt lgkmcnt(10)
  v_mfma_f32_32x32x16_bf16 v[120:135], v[72:75], v[60:63], v[120:135]
  ds_read_b64_tr_b16 v[44:45], v7 offset:0
  v_mfma_f32_32x32x16_bf16 v[136:151], v[72:75], v[64:67], v[136:151]
  ds_read_b64_tr_b16 v[46:47], v7 offset:256
  s_waitcnt lgkmcnt(10)
  v_mfma_f32_32x32x16_bf16 v[152:167], v[76:79], v[60:63], v[152:167]
  ds_read_b64_tr_b16 v[48:49], v8 offset:0
  v_mfma_f32_32x32x16_bf16 v[168:183], v[76:79], v[64:67], v[168:183]
  ds_read_b64_tr_b16 v[50:51], v8 offset:256
  s_waitcnt lgkmcnt(10)
  v_mfma_f32_32x32x16_bf16 v[184:199], v[80:83], v[60:63], v[184:199]
  ds_read_b64_tr_b16 v[52:53], v9 offset:0
  v_mfma_f32_32x32x16_bf16 v[200:215], v[80:83], v[64:67], v[200:215]
  ds_read_b64_tr_b16 v[54:55], v9 offset:256
  s_waitcnt lgkmcnt(10)
  v_mfma_f32_32x32x16_bf16 v[216:231], v[84:87], v[60:63], v[216:231]
  ds_read_b64_tr_b16 v[56:57], v10 offset:0
  v_mfma_f32_32x32x16_bf16 v[232:247], v[84:87], v[64:67], v[232:247]
  ds_read_b64_tr_b16 v[58:59], v10 offset:256
  s_waitcnt lgkmcnt(9)
  v_mfma_f32_32x32x16_bf16 v[88:103], v[40:43], v[32:35], v[88:103]
  ds_read_b128 v[60:63], v3 offset:32768
  ds_read_b64_tr_b16 v[68:69], v6 offset:2048
  s_waitcnt lgkmcnt(10)
  v_mfma_f32_32x32x16_bf16 v[104:119], v[40:43], v[36:39], v[104:119]
  ds_read_b64_tr_b16 v[70:71], v6 offset:2304
  ds_read_b128 v[64:67], v3 offset:36864
  s_waitcnt lgkmcnt(10)
  v_mfma_f32_32x32x16_bf16 v[120:135], v[44:47], v[32:35], v[120:135]
  ds_read_b64_tr_b16 v[72:73], v7 offset:2048
  v_mfma_f32_32x32x16_bf16 v[136:151], v[44:47], v[36:39], v[136:151]
  ds_read_b64_tr_b16 v[74:75], v7 offset:2304
  s_waitcnt lgkmcnt(10)
  v_mfma_f32_32x32x16_bf16 v[152:167], v[48:51], v[32:35], v[152:167]
  ds_read_b64_tr_b16 v[76:77], v8 offset:2048
  v_mfma_f32_32x32x16_bf16 v[168:183], v[48:51], v[36:39], v[168:183]
  ds_read_b64_tr_b16 v[78:79], v8 offset:2304
  s_waitcnt lgkmcnt(10)
  v_mfma_f32_32x32x16_bf16 v[184:199], v[52:55], v[32:35], v[184:199]
  ds_read_b64_tr_b16 v[80:81], v9 offset:2048
  v_mfma_f32_32x32x16_bf16 v[200:215], v[52:55], v[36:39], v[200:215]
  ds_read_b64_tr_b16 v[82:83], v9 offset:2304
  s_waitcnt lgkmcnt(10)
  v_mfma_f32_32x32x16_bf16 v[216:231], v[56:59], v[32:35], v[216:231]
  ds_read_b64_tr_b16 v[84:85], v10 offset:2048
  v_mfma_f32_32x32x16_bf16 v[232:247], v[56:59], v[36:39], v[232:247]
  ds_read_b64_tr_b16 v[86:87], v10 offset:2304
  s_barrier
  s_waitcnt lgkmcnt(9)
  v_mfma_f32_32x32x16_bf16 v[88:103], v[68:71], v[60:63], v[88:103]
  ds_read_b128 v[32:35], v4 offset:32768
  ds_read_b64_tr_b16 v[40:41], v6 offset:20480
  s_waitcnt lgkmcnt(10)
  v_mfma_f32_32x32x16_bf16 v[104:119], v[68:71], v[64:67], v[104:119]
  ds_read_b64_tr_b16 v[42:43], v6 offset:20736
  ds_read_b128 v[36:39], v4 offset:36864
  s_waitcnt lgkmcnt(10)
  v_mfma_f32_32x32x16_bf16 v[120:135], v[72:75], v[60:63], v[120:135]
  ds_read_b64_tr_b16 v[44:45], v7 offset:20480
  v_mfma_f32_32x32x16_bf16 v[136:151], v[72:75], v[64:67], v[136:151]
  ds_read_b64_tr_b16 v[46:47], v7 offset:20736
  s_waitcnt lgkmcnt(10)
  v_mfma_f32_32x32x16_bf16 v[152:167], v[76:79], v[60:63], v[152:167]
  ds_read_b64_tr_b16 v[48:49], v8 offset:20480
  v_mfma_f32_32x32x16_bf16 v[168:183], v[76:79], v[64:67], v[168:183]
  ds_read_b64_tr_b16 v[50:51], v8 offset:20736
  s_waitcnt lgkmcnt(10)
  v_mfma_f32_32x32x16_bf16 v[184:199], v[80:83], v[60:63], v[184:199]
  ds_read_b64_tr_b16 v[52:53], v9 offset:20480
  v_mfma_f32_32x32x16_bf16 v[200:215], v[80:83], v[64:67], v[200:215]
  ds_read_b64_tr_b16 v[54:55], v9 offset:20736
  s_waitcnt lgkmcnt(10)
  v_mfma_f32_32x32x16_bf16 v[216:231], v[84:87], v[60:63], v[216:231]
  ds_read_b64_tr_b16 v[56:57], v10 offset:20480
  v_mfma_f32_32x32x16_bf16 v[232:247], v[84:87], v[64:67], v[232:247]
  ds_read_b64_tr_b16 v[58:59], v10 offset:20736
  s_waitcnt lgkmcnt(9)
  v_mfma_f32_32x32x16_bf16 v[88:103], v[40:43], v[32:35], v[88:103]
  ds_read_b128 v[60:63], v5 offset:32768
  ds_read_b64_tr_b16 v[68:69], v6 offset:22528
  s_waitcnt lgkmcnt(10)
  v_mfma_f32_32x32x16_bf16 v[104:119], v[40:43], v[36:39], v[104:119]
  ds_read_b64_tr_b16 v[70:71], v6 offset:22784
  ds_read_b128 v[64:67], v5 offset:36864
  s_waitcnt lgkmcnt(10)
  v_mfma_f32_32x32x16_bf16 v[120:135], v[44:47], v[32:35], v[120:135]
  ds_read_b64_tr_b16 v[72:73], v7 offset:22528
  v_mfma_f32_32x32x16_bf16 v[136:151], v[44:47], v[36:39], v[136:151]
  ds_read_b64_tr_b16 v[74:75], v7 offset:22784
  s_waitcnt lgkmcnt(10)
  v_mfma_f32_32x32x16_bf16 v[152:167], v[48:51], v[32:35], v[152:167]
  ds_read_b64_tr_b16 v[76:77], v8 offset:22528
  v_mfma_f32_32x32x16_bf16 v[168:183], v[48:51], v[36:39], v[168:183]
  ds_read_b64_tr_b16 v[78:79], v8 offset:22784
  s_waitcnt lgkmcnt(10)
  v_mfma_f32_32x32x16_bf16 v[184:199], v[52:55], v[32:35], v[184:199]
  ds_read_b64_tr_b16 v[80:81], v9 offset:22528
  v_mfma_f32_32x32x16_bf16 v[200:215], v[52:55], v[36:39], v[200:215]
  ds_read_b64_tr_b16 v[82:83], v9 offset:22784
  s_waitcnt lgkmcnt(10)
  v_mfma_f32_32x32x16_bf16 v[216:231], v[56:59], v[32:35], v[216:231]
  ds_read_b64_tr_b16 v[84:85], v10 offset:22528
  v_mfma_f32_32x32x16_bf16 v[232:247], v[56:59], v[36:39], v[232:247]
  ds_read_b64_tr_b16 v[86:87], v10 offset:22784
  s_barrier
  s_waitcnt lgkmcnt(9)
  v_mfma_f32_32x32x16_bf16 v[88:103], v[68:71], v[60:63], v[88:103]
  ds_read_b128 v[32:35], v2 offset:0
  ds_read_b64_tr_b16 v[40:41], v6 offset:40960
  s_waitcnt lgkmcnt(10)
  v_mfma_f32_32x32x16_bf16 v[104:119], v[68:71], v[64:67], v[104:119]
  ds_read_b64_tr_b16 v[42:43], v6 offset:41216
  ds_read_b128 v[36:39], v2 offset:4096
  s_waitcnt lgkmcnt(10)
  v_mfma_f32_32x32x16_bf16 v[120:135], v[72:75], v[60:63], v[120:135]
  ds_read_b64_tr_b16 v[44:45], v7 offset:40960
  v_mfma_f32_32x32x16_bf16 v[136:151], v[72:75], v[64:67], v[136:151]
  ds_read_b64_tr_b16 v[46:47], v7 offset:41216
  s_waitcnt lgkmcnt(10)
  v_mfma_f32_32x32x16_bf16 v[152:167], v[76:79], v[60:63], v[152:167]
  ds_read_b64_tr_b16 v[48:49], v8 offset:40960
  v_mfma_f32_32x32x16_bf16 v[168:183], v[76:79], v[64:67], v[168:183]
  ds_read_b64_tr_b16 v[50:51], v8 offset:41216
  s_waitcnt lgkmcnt(10)
  v_mfma_f32_32x32x16_bf16 v[184:199], v[80:83], v[60:63], v[184:199]
  ds_read_b64_tr_b16 v[52:53], v9 offset:40960
  v_mfma_f32_32x32x16_bf16 v[200:215], v[80:83], v[64:67], v[200:215]
  ds_read_b64_tr_b16 v[54:55], v9 offset:41216
  s_waitcnt lgkmcnt(10)
  v_mfma_f32_32x32x16_bf16 v[216:231], v[84:87], v[60:63], v[216:231]
  ds_read_b64_tr_b16 v[56:57], v10 offset:40960
  v_mfma_f32_32x32x16_bf16 v[232:247], v[84:87], v[64:67], v[232:247]
  ds_read_b64_tr_b16 v[58:59], v10 offset:41216
  s_waitcnt lgkmcnt(9)
  v_mfma_f32_32x32x16_bf16 v[88:103], v[40:43], v[32:35], v[88:103]
  ds_read_b128 v[60:63], v3 offset:0
  ds_read_b64_tr_b16 v[68:69], v6 offset:43008
  s_waitcnt lgkmcnt(10)
  v_mfma_f32_32x32x16_bf16 v[104:119], v[40:43], v[36:39], v[104:119]
  ds_read_b64_tr_b16 v[70:71], v6 offset:43264
  ds_read_b128 v[64:67], v3 offset:4096
  s_waitcnt lgkmcnt(10)
  v_mfma_f32_32x32x16_bf16 v[120:135], v[44:47], v[32:35], v[120:135]
  ds_read_b64_tr_b16 v[72:73], v7 offset:43008
  v_mfma_f32_32x32x16_bf16 v[136:151], v[44:47], v[36:39], v[136:151]
  ds_read_b64_tr_b16 v[74:75], v7 offset:43264
  s_waitcnt lgkmcnt(10)
  v_mfma_f32_32x32x16_bf16 v[152:167], v[48:51], v[32:35], v[152:167]
  ds_read_b64_tr_b16 v[76:77], v8 offset:43008
  v_mfma_f32_32x32x16_bf16 v[168:183], v[48:51], v[36:39], v[168:183]
  ds_read_b64_tr_b16 v[78:79], v8 offset:43264
  s_waitcnt lgkmcnt(10)
  v_mfma_f32_32x32x16_bf16 v[184:199], v[52:55], v[32:35], v[184:199]
  ds_read_b64_tr_b16 v[80:81], v9 offset:43008
  v_mfma_f32_32x32x16_bf16 v[200:215], v[52:55], v[36:39], v[200:215]
  ds_read_b64_tr_b16 v[82:83], v9 offset:43264
  s_waitcnt lgkmcnt(10)
  v_mfma_f32_32x32x16_bf16 v[216:231], v[56:59], v[32:35], v[216:231]
  ds_read_b64_tr_b16 v[84:85], v10 offset:43008
  v_mfma_f32_32x32x16_bf16 v[232:247], v[56:59], v[36:39], v[232:247]
  ds_read_b64_tr_b16 v[86:87], v10 offset:43264
  s_barrier
  s_waitcnt lgkmcnt(9)
  v_mfma_f32_32x32x16_bf16 v[88:103], v[68:71], v[60:63], v[88:103]
  ds_read_b128 v[32:35], v4 offset:0
  ds_read_b64_tr_b16 v[40:41], v6 offset:61440
  s_waitcnt lgkmcnt(10)
  v_mfma_f32_32x32x16_bf16 v[104:119], v[68:71], v[64:67], v[104:119]
  ds_read_b64_tr_b16 v[42:43], v6 offset:61696
  ds_read_b128 v[36:39], v4 offset:4096
  s_waitcnt lgkmcnt(10)
  v_mfma_f32_32x32x16_bf16 v[120:135], v[72:75], v[60:63], v[120:135]
  ds_read_b64_tr_b16 v[44:45], v7 offset:61440
  v_mfma_f32_32x32x16_bf16 v[136:151], v[72:75], v[64:67], v[136:151]
  ds_read_b64_tr_b16 v[46:47], v7 offset:61696
  s_waitcnt lgkmcnt(10)
  v_mfma_f32_32x32x16_bf16 v[152:167], v[76:79], v[60:63], v[152:167]
  ds_read_b64_tr_b16 v[48:49], v8 offset:61440
  v_mfma_f32_32x32x16_bf16 v[168:183], v[76:79], v[64:67], v[168:183]
  ds_read_b64_tr_b16 v[50:51], v8 offset:61696
  s_waitcnt lgkmcnt(10)
  v_mfma_f32_32x32x16_bf16 v[184:199], v[80:83], v[60:63], v[184:199]
  ds_read_b64_tr_b16 v[52:53], v9 offset:61440
  v_mfma_f32_32x32x16_bf16 v[200:215], v[80:83], v[64:67], v[200:215]
  ds_read_b64_tr_b16 v[54:55], v9 offset:61696
  s_waitcnt lgkmcnt(10)
  v_mfma_f32_32x32x16_bf16 v[216:231], v[84:87], v[60:63], v[216:231]
  ds_read_b64_tr_b16 v[56:57], v10 offset:61440
  v_mfma_f32_32x32x16_bf16 v[232:247], v[84:87], v[64:67], v[232:247]
  ds_read_b64_tr_b16 v[58:59], v10 offset:61696
  s_waitcnt lgkmcnt(9)
  v_mfma_f32_32x32x16_bf16 v[88:103], v[40:43], v[32:35], v[88:103]
  ds_read_b128 v[60:63], v5 offset:0
  ds_read_b64_tr_b16 v[68:69], v6 offset:63488
  s_waitcnt lgkmcnt(10)
  v_mfma_f32_32x32x16_bf16 v[104:119], v[40:43], v[36:39], v[104:119]
  ds_read_b64_tr_b16 v[70:71], v6 offset:63744
  ds_read_b128 v[64:67], v5 offset:4096
  s_waitcnt lgkmcnt(10)
  v_mfma_f32_32x32x16_bf16 v[120:135], v[44:47], v[32:35], v[120:135]
  ds_read_b64_tr_b16 v[72:73], v7 offset:63488
  v_mfma_f32_32x32x16_bf16 v[136:151], v[44:47], v[36:39], v[136:151]
  ds_read_b64_tr_b16 v[74:75], v7 offset:63744
  s_waitcnt lgkmcnt(10)
  v_mfma_f32_32x32x16_bf16 v[152:167], v[48:51], v[32:35], v[152:167]
  ds_read_b64_tr_b16 v[76:77], v8 offset:63488
  v_mfma_f32_32x32x16_bf16 v[168:183], v[48:51], v[36:39], v[168:183]
  ds_read_b64_tr_b16 v[78:79], v8 offset:63744
  s_waitcnt lgkmcnt(10)
  v_mfma_f32_32x32x16_bf16 v[184:199], v[52:55], v[32:35], v[184:199]
  ds_read_b64_tr_b16 v[80:81], v9 offset:63488
  v_mfma_f32_32x32x16_bf16 v[200:215], v[52:55], v[36:39], v[200:215]
  ds_read_b64_tr_b16 v[82:83], v9 offset:63744
  s_waitcnt lgkmcnt(10)
  v_mfma_f32_32x32x16_bf16 v[216:231], v[56:59], v[32:35], v[216:231]
  ds_read_b64_tr_b16 v[84:85], v10 offset:63488
  v_mfma_f32_32x32x16_bf16 v[232:247], v[56:59], v[36:39], v[232:247]
  ds_read_b64_tr_b16 v[86:87], v10 offset:63744
  s_barrier
  s_waitcnt lgkmcnt(9)
  v_mfma_f32_32x32x16_bf16 v[88:103], v[68:71], v[60:63], v[88:103]
  ds_read_b128 v[32:35], v2 offset:16384
  ds_read_b64_tr_b16 v[40:41], v11 offset:0
  s_waitcnt lgkmcnt(10)
  v_mfma_f32_32x32x16_bf16 v[104:119], v[68:71], v[64:67], v[104:119]
  ds_read_b64_tr_b16 v[42:43], v11 offset:256
  ds_read_b128 v[36:39], v2 offset:20480
  s_waitcnt lgkmcnt(10)
  v_mfma_f32_32x32x16_bf16 v[120:135], v[72:75], v[60:63], v[120:135]
  ds_read_b64_tr_b16 v[44:45], v12 offset:0
  v_mfma_f32_32x32x16_bf16 v[136:151], v[72:75], v[64:67], v[136:151]
  ds_read_b64_tr_b16 v[46:47], v12 offset:256
  s_waitcnt lgkmcnt(10)
  v_mfma_f32_32x32x16_bf16 v[152:167], v[76:79], v[60:63], v[152:167]
  ds_read_b64_tr_b16 v[48:49], v13 offset:0
  v_mfma_f32_32x32x16_bf16 v[168:183], v[76:79], v[64:67], v[168:183]
  ds_read_b64_tr_b16 v[50:51], v13 offset:256
  s_waitcnt lgkmcnt(10)
  v_mfma_f32_32x32x16_bf16 v[184:199], v[80:83], v[60:63], v[184:199]
  ds_read_b64_tr_b16 v[52:53], v14 offset:0
  v_mfma_f32_32x32x16_bf16 v[200:215], v[80:83], v[64:67], v[200:215]
  ds_read_b64_tr_b16 v[54:55], v14 offset:256
  s_waitcnt lgkmcnt(10)
  v_mfma_f32_32x32x16_bf16 v[216:231], v[84:87], v[60:63], v[216:231]
  ds_read_b64_tr_b16 v[56:57], v15 offset:0
  v_mfma_f32_32x32x16_bf16 v[232:247], v[84:87], v[64:67], v[232:247]
  ds_read_b64_tr_b16 v[58:59], v15 offset:256
  s_waitcnt lgkmcnt(9)
  v_mfma_f32_32x32x16_bf16 v[88:103], v[40:43], v[32:35], v[88:103]
  ds_read_b128 v[60:63], v3 offset:16384
  ds_read_b64_tr_b16 v[68:69], v11 offset:2048
  s_waitcnt lgkmcnt(10)
  v_mfma_f32_32x32x16_bf16 v[104:119], v[40:43], v[36:39], v[104:119]
  ds_read_b64_tr_b16 v[70:71], v11 offset:2304
  ds_read_b128 v[64:67], v3 offset:20480
  s_waitcnt lgkmcnt(10)
  v_mfma_f32_32x32x16_bf16 v[120:135], v[44:47], v[32:35], v[120:135]
  ds_read_b64_tr_b16 v[72:73], v12 offset:2048
  v_mfma_f32_32x32x16_bf16 v[136:151], v[44:47], v[36:39], v[136:151]
  ds_read_b64_tr_b16 v[74:75], v12 offset:2304
  s_waitcnt lgkmcnt(10)
  v_mfma_f32_32x32x16_bf16 v[152:167], v[48:51], v[32:35], v[152:167]
  ds_read_b64_tr_b16 v[76:77], v13 offset:2048
  v_mfma_f32_32x32x16_bf16 v[168:183], v[48:51], v[36:39], v[168:183]
  ds_read_b64_tr_b16 v[78:79], v13 offset:2304
  s_waitcnt lgkmcnt(10)
  v_mfma_f32_32x32x16_bf16 v[184:199], v[52:55], v[32:35], v[184:199]
  ds_read_b64_tr_b16 v[80:81], v14 offset:2048
  v_mfma_f32_32x32x16_bf16 v[200:215], v[52:55], v[36:39], v[200:215]
  ds_read_b64_tr_b16 v[82:83], v14 offset:2304
  s_waitcnt lgkmcnt(10)
  v_mfma_f32_32x32x16_bf16 v[216:231], v[56:59], v[32:35], v[216:231]
  ds_read_b64_tr_b16 v[84:85], v15 offset:2048
  v_mfma_f32_32x32x16_bf16 v[232:247], v[56:59], v[36:39], v[232:247]
  ds_read_b64_tr_b16 v[86:87], v15 offset:2304
  s_barrier
  s_waitcnt lgkmcnt(9)
  v_mfma_f32_32x32x16_bf16 v[88:103], v[68:71], v[60:63], v[88:103]
  ds_read_b128 v[32:35], v4 offset:16384
  ds_read_b64_tr_b16 v[40:41], v6 offset:0
  s_waitcnt lgkmcnt(10)
  v_mfma_f32_32x32x16_bf16 v[104:119], v[68:71], v[64:67], v[104:119]
  ds_read_b64_tr_b16 v[42:43], v6 offset:256
  ds_read_b128 v[36:39], v4 offset:20480
  s_waitcnt lgkmcnt(10)
  v_mfma_f32_32x32x16_bf16 v[120:135], v[72:75], v[60:63], v[120:135]
  ds_read_b64_tr_b16 v[44:45], v7 offset:0
  v_mfma_f32_32x32x16_bf16 v[136:151], v[72:75], v[64:67], v[136:151]
  ds_read_b64_tr_b16 v[46:47], v7 offset:256
  s_waitcnt lgkmcnt(10)
  v_mfma_f32_32x32x16_bf16 v[152:167], v[76:79], v[60:63], v[152:167]
  ds_read_b64_tr_b16 v[48:49], v8 offset:0
  v_mfma_f32_32x32x16_bf16 v[168:183], v[76:79], v[64:67], v[168:183]
  ds_read_b64_tr_b16 v[50:51], v8 offset:256
  s_waitcnt lgkmcnt(10)
  v_mfma_f32_32x32x16_bf16 v[184:199], v[80:83], v[60:63], v[184:199]
  ds_read_b64_tr_b16 v[52:53], v9 offset:0
  v_mfma_f32_32x32x16_bf16 v[200:215], v[80:83], v[64:67], v[200:215]
  ds_read_b64_tr_b16 v[54:55], v9 offset:256
  s_waitcnt lgkmcnt(10)
  v_mfma_f32_32x32x16_bf16 v[216:231], v[84:87], v[60:63], v[216:231]
  ds_read_b64_tr_b16 v[56:57], v10 offset:0
  v_mfma_f32_32x32x16_bf16 v[232:247], v[84:87], v[64:67], v[232:247]
  ds_read_b64_tr_b16 v[58:59], v10 offset:256
  s_waitcnt lgkmcnt(9)
  v_mfma_f32_32x32x16_bf16 v[88:103], v[40:43], v[32:35], v[88:103]
  ds_read_b128 v[60:63], v5 offset:16384
  ds_read_b64_tr_b16 v[68:69], v6 offset:2048
  s_waitcnt lgkmcnt(10)
  v_mfma_f32_32x32x16_bf16 v[104:119], v[40:43], v[36:39], v[104:119]
  ds_read_b64_tr_b16 v[70:71], v6 offset:2304
  ds_read_b128 v[64:67], v5 offset:20480
  s_waitcnt lgkmcnt(10)
  v_mfma_f32_32x32x16_bf16 v[120:135], v[44:47], v[32:35], v[120:135]
  ds_read_b64_tr_b16 v[72:73], v7 offset:2048
  v_mfma_f32_32x32x16_bf16 v[136:151], v[44:47], v[36:39], v[136:151]
  ds_read_b64_tr_b16 v[74:75], v7 offset:2304
  s_waitcnt lgkmcnt(10)
  v_mfma_f32_32x32x16_bf16 v[152:167], v[48:51], v[32:35], v[152:167]
  ds_read_b64_tr_b16 v[76:77], v8 offset:2048
  v_mfma_f32_32x32x16_bf16 v[168:183], v[48:51], v[36:39], v[168:183]
  ds_read_b64_tr_b16 v[78:79], v8 offset:2304
  s_waitcnt lgkmcnt(10)
  v_mfma_f32_32x32x16_bf16 v[184:199], v[52:55], v[32:35], v[184:199]
  ds_read_b64_tr_b16 v[80:81], v9 offset:2048
  v_mfma_f32_32x32x16_bf16 v[200:215], v[52:55], v[36:39], v[200:215]
  ds_read_b64_tr_b16 v[82:83], v9 offset:2304
  s_waitcnt lgkmcnt(10)
  v_mfma_f32_32x32x16_bf16 v[216:231], v[56:59], v[32:35], v[216:231]
  ds_read_b64_tr_b16 v[84:85], v10 offset:2048
  v_mfma_f32_32x32x16_bf16 v[232:247], v[56:59], v[36:39], v[232:247]
  ds_read_b64_tr_b16 v[86:87], v10 offset:2304
  s_barrier
  s_waitcnt lgkmcnt(9)
  v_mfma_f32_32x32x16_bf16 v[88:103], v[68:71], v[60:63], v[88:103]
  ds_read_b128 v[32:35], v22
  ds_read_b128 v[36:39], v22 offset:1024
  s_waitcnt lgkmcnt(10)
  v_mfma_f32_32x32x16_bf16 v[104:119], v[68:71], v[64:67], v[104:119]
  ds_read_b128 v[16:19], v22 offset:16
  ds_read_b128 v[28:31], v22 offset:1040
  s_waitcnt lgkmcnt(10)
  v_mfma_f32_32x32x16_bf16 v[120:135], v[72:75], v[60:63], v[120:135]
  ds_read_b32 v40, v23
  v_mfma_f32_32x32x16_bf16 v[136:151], v[72:75], v[64:67], v[136:151]
  ds_read_b32 v44, v24
  s_waitcnt lgkmcnt(10)
  v_mfma_f32_32x32x16_bf16 v[152:167], v[76:79], v[60:63], v[152:167]
  ds_read_b32 v48, v25
  v_mfma_f32_32x32x16_bf16 v[168:183], v[76:79], v[64:67], v[168:183]
  ds_read_b32 v52, v26
  s_waitcnt lgkmcnt(10)
  v_mfma_f32_32x32x16_bf16 v[184:199], v[80:83], v[60:63], v[184:199]
  ds_read_b32 v56, v27
  v_mfma_f32_32x32x16_bf16 v[200:215], v[80:83], v[64:67], v[200:215]
  s_waitcnt lgkmcnt(9)
  v_mfma_f32_32x32x16_bf16 v[216:231], v[84:87], v[60:63], v[216:231]
  v_mfma_f32_32x32x16_bf16 v[232:247], v[84:87], v[64:67], v[232:247]
  s_waitcnt lgkmcnt(0)
  s_barrier
  v_mov_b32 v248, v34
  v_mov_b32 v249, v35
  v_mov_b32 v250, v16
  v_mov_b32 v251, v17
  v_mov_b32 v252, v38
  v_mov_b32 v253, v39
  v_mov_b32 v254, v28
  v_mov_b32 v255, v29
  v_cmp_gt_u32 vcc, 32, v1
  v_readfirstlane_b32 s80, v18
  v_mov_b32 v34, 0
  v_mov_b32 v35, 0
  v_mov_b32 v38, 0
  v_mov_b32 v39, 0
  v_cndmask_b32 v32, 0, v32, vcc
  v_cndmask_b32 v33, 0, v33, vcc
  v_cndmask_b32 v36, 0, v36, vcc
  v_cndmask_b32 v37, 0, v37, vcc
  v_mov_b32 v57, v56
  v_mov_b32 v58, 0
  v_mov_b32 v59, 0
  v_mov_b32 v53, v52
  v_mov_b32 v54, 0
  v_mov_b32 v55, 0
  v_mov_b32 v49, v48
  v_mov_b32 v50, 0
  v_mov_b32 v51, 0
  v_mov_b32 v45, v44
  v_mov_b32 v46, 0
  v_mov_b32 v47, 0
  v_mov_b32 v41, v40
  v_mov_b32 v42, 0
  v_mov_b32 v43, 0
  v_mfma_f32_32x32x16_bf16 v[216:231], v[56:59], v[32:35], v[216:231]
  v_mfma_f32_32x32x16_bf16 v[232:247], v[56:59], v[36:39], v[232:247]
  v_mfma_f32_32x32x16_bf16 v[184:199], v[52:55], v[32:35], v[184:199]
  v_mfma_f32_32x32x16_bf16 v[200:215], v[52:55], v[36:39], v[200:215]
  v_mfma_f32_32x32x16_bf16 v[152:167], v[48:51], v[32:35], v[152:167]
  v_mfma_f32_32x32x16_bf16 v[168:183], v[48:51], v[36:39], v[168:183]
  v_mfma_f32_32x32x16_bf16 v[120:135], v[44:47], v[32:35], v[120:135]
  v_mfma_f32_32x32x16_bf16 v[136:151], v[44:47], v[36:39], v[136:151]
  v_mfma_f32_32x32x16_bf16 v[88:103], v[40:43], v[32:35], v[88:103]
  v_mfma_f32_32x32x16_bf16 v[104:119], v[40:43], v[36:39], v[104:119]
  v_lshlrev_b32 v2, 4, v1
  v_and_b32 v3, 31, v1
  v_lshlrev_b32 v3, 5, v3
  v_lshrrev_b32 v4, 5, v1
  v_lshlrev_b32 v4, 4, v4
  v_add_u32 v3, v3, v4
  v_lshlrev_b32 v8, 8, v1
  v_mov_b32 v9, s80
  v_mov_b32 v68, v249
  v_mov_b32 v69, v249
  v_mov_b32 v70, v250
  v_mov_b32 v71, v250
  v_mov_b32 v72, v251
  v_mov_b32 v73, v251
  v_mov_b32 v74, v253
  v_mov_b32 v75, v253
  v_mov_b32 v76, v254
  v_mov_b32 v77, v254
  v_mov_b32 v78, v255
  v_mov_b32 v79, v255
  s_cmp_eq_u32 s50, 1
  s_cbranch_scc1 M_TC
  s_add_u32 s60, s54, 0
  s_cmp_lt_u32 s60, 8
  s_mov_b32 s62, 0x3eb8aa3b
  s_cselect_b32 s62, s62, 1.0
  v_mul_f32 v4, s62, v248
  v_mul_f32 v6, s62, v252
  v_mul_f32 v5, s62, v248
  v_mul_f32_e64 v7, s62, v252
  v_pk_mul_f32 v[216:217], v[216:217], v[4:5]
  v_pk_mul_f32 v[218:219], v[218:219], v[4:5]
  v_pk_mul_f32 v[220:221], v[220:221], v[4:5]
  v_pk_mul_f32 v[222:223], v[222:223], v[4:5]
  v_pk_mul_f32 v[224:225], v[224:225], v[4:5]
  v_pk_mul_f32 v[226:227], v[226:227], v[4:5]
  v_pk_mul_f32 v[228:229], v[228:229], v[4:5]
  v_pk_mul_f32 v[230:231], v[230:231], v[4:5]
  v_cvt_pk_bf16_f32 v216, v216, v217
  v_cvt_pk_bf16_f32 v217, v218, v219
  v_cvt_pk_bf16_f32 v218, v220, v221
  v_cvt_pk_bf16_f32 v219, v222, v223
  v_cvt_pk_bf16_f32 v220, v224, v225
  v_cvt_pk_bf16_f32 v221, v226, v227
  v_cvt_pk_bf16_f32 v222, v228, v229
  v_cvt_pk_bf16_f32 v223, v230, v231
  s_add_u32 s63, s71, 0
  buffer_store_dwordx4 v[216:219], v2, s[20:23], s63 offen sc1
  s_nop 0
  s_add_u32 s63, s63, 65536
  buffer_store_dwordx4 v[220:223], v2, s[20:23], s63 offen sc1
  v_pk_mul_f32 v[232:233], v[232:233], v[6:7]
  v_pk_mul_f32 v[234:235], v[234:235], v[6:7]
  v_pk_mul_f32 v[236:237], v[236:237], v[6:7]
  v_pk_mul_f32 v[238:239], v[238:239], v[6:7]
  v_pk_mul_f32 v[240:241], v[240:241], v[6:7]
  v_pk_mul_f32 v[242:243], v[242:243], v[6:7]
  v_pk_mul_f32 v[244:245], v[244:245], v[6:7]
  v_pk_mul_f32 v[246:247], v[246:247], v[6:7]
  v_cvt_pk_bf16_f32 v232, v232, v233
  v_cvt_pk_bf16_f32 v233, v234, v235
  v_cvt_pk_bf16_f32 v234, v236, v237
  v_cvt_pk_bf16_f32 v235, v238, v239
  v_cvt_pk_bf16_f32 v236, v240, v241
  v_cvt_pk_bf16_f32 v237, v242, v243
  v_cvt_pk_bf16_f32 v238, v244, v245
  v_cvt_pk_bf16_f32 v239, v246, v247
  s_add_u32 s63, s71, 1024
  buffer_store_dwordx4 v[232:235], v2, s[20:23], s63 offen sc1
  s_add_u32 s63, s63, 65536
  buffer_store_dwordx4 v[236:239], v2, s[20:23], s63 offen sc1
  v_pk_mul_f32 v[60:61], v[184:185], v[184:185]
  v_pk_mul_f32 v[62:63], v[186:187], v[186:187]
  v_pk_mul_f32 v[64:65], v[188:189], v[188:189]
  v_pk_mul_f32 v[66:67], v[190:191], v[190:191]
  v_pk_fma_f32 v[60:61], v[60:61], v[70:71], v[68:69]
  v_pk_fma_f32 v[62:63], v[62:63], v[70:71], v[68:69]
  v_pk_fma_f32 v[64:65], v[64:65], v[70:71], v[68:69]
  v_pk_fma_f32 v[66:67], v[66:67], v[70:71], v[68:69]
  v_pk_mul_f32 v[60:61], v[60:61], v[184:185]
  v_pk_mul_f32 v[62:63], v[62:63], v[186:187]
  v_pk_mul_f32 v[64:65], v[64:65], v[188:189]
  v_pk_mul_f32 v[66:67], v[66:67], v[190:191]
  v_exp_f32 v60, v60
  v_exp_f32 v61, v61
  v_exp_f32 v62, v62
  v_exp_f32 v63, v63
  v_exp_f32 v64, v64
  v_exp_f32 v65, v65
  v_exp_f32 v66, v66
  v_exp_f32 v67, v67
  v_pk_mul_f32 v[184:185], v[184:185], v[192:193]
  v_pk_mul_f32 v[186:187], v[186:187], v[194:195]
  v_pk_mul_f32 v[188:189], v[188:189], v[196:197]
  v_pk_mul_f32 v[190:191], v[190:191], v[198:199]
  v_pk_fma_f32 v[60:61], v[60:61], v[72:73], v[72:73]
  v_pk_fma_f32 v[62:63], v[62:63], v[72:73], v[72:73]
  v_pk_fma_f32 v[64:65], v[64:65], v[72:73], v[72:73]
  v_pk_fma_f32 v[66:67], v[66:67], v[72:73], v[72:73]
  v_rcp_f32 v60, v60
  v_rcp_f32 v61, v61
  v_rcp_f32 v62, v62
  v_rcp_f32 v63, v63
  v_rcp_f32 v64, v64
  v_rcp_f32 v65, v65
  v_rcp_f32 v66, v66
  v_rcp_f32_e64 v67, v67
  s_nop 0
  v_pk_mul_f32 v[184:185], v[184:185], v[60:61]
  v_pk_mul_f32 v[186:187], v[186:187], v[62:63]
  v_pk_mul_f32 v[188:189], v[188:189], v[64:65]
  v_pk_mul_f32 v[190:191], v[190:191], v[66:67]
  v_cvt_pk_bf16_f32 v192, v184, v185
  v_cvt_pk_bf16_f32 v193, v186, v187
  v_cvt_pk_bf16_f32 v194, v188, v189
  v_cvt_pk_bf16_f32 v195, v190, v191
  v_pk_mul_f32 v[60:61], v[200:201], v[200:201]
  v_pk_mul_f32 v[62:63], v[202:203], v[202:203]
  v_pk_mul_f32 v[64:65], v[204:205], v[204:205]
  v_pk_mul_f32 v[66:67], v[206:207], v[206:207]
  v_pk_fma_f32 v[60:61], v[60:61], v[76:77], v[74:75]
  v_pk_fma_f32 v[62:63], v[62:63], v[76:77], v[74:75]
  v_pk_fma_f32 v[64:65], v[64:65], v[76:77], v[74:75]
  v_pk_fma_f32 v[66:67], v[66:67], v[76:77], v[74:75]
  v_pk_mul_f32 v[60:61], v[60:61], v[200:201]
  v_pk_mul_f32 v[62:63], v[62:63], v[202:203]
  v_pk_mul_f32 v[64:65], v[64:65], v[204:205]
  v_pk_mul_f32 v[66:67], v[66:67], v[206:207]
  v_exp_f32 v60, v60
  v_exp_f32 v61, v61
  v_exp_f32 v62, v62
  v_exp_f32 v63, v63
  v_exp_f32 v64, v64
  v_exp_f32 v65, v65
  v_exp_f32 v66, v66
  v_exp_f32 v67, v67
  v_pk_mul_f32 v[200:201], v[200:201], v[208:209]
  v_pk_mul_f32 v[202:203], v[202:203], v[210:211]
  v_pk_mul_f32 v[204:205], v[204:205], v[212:213]
  v_pk_mul_f32 v[206:207], v[206:207], v[214:215]
  v_pk_fma_f32 v[60:61], v[60:61], v[78:79], v[78:79]
  v_pk_fma_f32 v[62:63], v[62:63], v[78:79], v[78:79]
  v_pk_fma_f32 v[64:65], v[64:65], v[78:79], v[78:79]
  v_pk_fma_f32 v[66:67], v[66:67], v[78:79], v[78:79]
  v_rcp_f32 v60, v60
  v_rcp_f32 v61, v61
  v_rcp_f32 v62, v62
  v_rcp_f32 v63, v63
  v_rcp_f32 v64, v64
  v_rcp_f32 v65, v65
  v_rcp_f32 v66, v66
  v_rcp_f32_e64 v67, v67
  s_nop 0
  v_pk_mul_f32 v[200:201], v[200:201], v[60:61]
  v_pk_mul_f32 v[202:203], v[202:203], v[62:63]
  v_pk_mul_f32 v[204:205], v[204:205], v[64:65]
  v_pk_mul_f32 v[206:207], v[206:207], v[66:67]
  v_cvt_pk_bf16_f32 v208, v200, v201
  v_cvt_pk_bf16_f32 v209, v202, v203
  v_cvt_pk_bf16_f32 v210, v204, v205
  v_cvt_pk_bf16_f32 v211, v206, v207
  s_barrier
  s_nop 0
  v_pk_mul_f32 v[60:61], v[152:153], v[152:153]
  v_pk_mul_f32 v[62:63], v[154:155], v[154:155]
  v_pk_mul_f32 v[64:65], v[156:157], v[156:157]
  v_pk_mul_f32 v[66:67], v[158:159], v[158:159]
  v_pk_fma_f32 v[60:61], v[60:61], v[70:71], v[68:69]
  v_pk_fma_f32 v[62:63], v[62:63], v[70:71], v[68:69]
  v_pk_fma_f32 v[64:65], v[64:65], v[70:71], v[68:69]
  v_pk_fma_f32 v[66:67], v[66:67], v[70:71], v[68:69]
  v_pk_mul_f32 v[60:61], v[60:61], v[152:153]
  v_pk_mul_f32 v[62:63], v[62:63], v[154:155]
  v_pk_mul_f32 v[64:65], v[64:65], v[156:157]
  v_pk_mul_f32 v[66:67], v[66:67], v[158:159]
  v_exp_f32 v60, v60
  v_exp_f32 v61, v61
  v_exp_f32 v62, v62
  v_exp_f32 v63, v63
  v_exp_f32 v64, v64
  v_exp_f32 v65, v65
  v_exp_f32 v66, v66
  v_exp_f32 v67, v67
  v_pk_mul_f32 v[152:153], v[152:153], v[160:161]
  v_pk_mul_f32 v[154:155], v[154:155], v[162:163]
  v_pk_mul_f32 v[156:157], v[156:157], v[164:165]
  v_pk_mul_f32 v[158:159], v[158:159], v[166:167]
  v_pk_fma_f32 v[60:61], v[60:61], v[72:73], v[72:73]
  v_pk_fma_f32 v[62:63], v[62:63], v[72:73], v[72:73]
  v_pk_fma_f32 v[64:65], v[64:65], v[72:73], v[72:73]
  v_pk_fma_f32 v[66:67], v[66:67], v[72:73], v[72:73]
  v_rcp_f32 v60, v60
  v_rcp_f32 v61, v61
  v_rcp_f32 v62, v62
  v_rcp_f32 v63, v63
  v_rcp_f32 v64, v64
  v_rcp_f32 v65, v65
  v_rcp_f32 v66, v66
  v_rcp_f32_e64 v67, v67
  s_nop 0
  v_pk_mul_f32 v[152:153], v[152:153], v[60:61]
  v_pk_mul_f32 v[154:155], v[154:155], v[62:63]
  v_pk_mul_f32 v[156:157], v[156:157], v[64:65]
  v_pk_mul_f32 v[158:159], v[158:159], v[66:67]
  v_cvt_pk_bf16_f32 v160, v152, v153
  v_cvt_pk_bf16_f32 v161, v154, v155
  v_cvt_pk_bf16_f32 v162, v156, v157
  v_cvt_pk_bf16_f32 v163, v158, v159
  v_pk_mul_f32 v[60:61], v[168:169], v[168:169]
  v_pk_mul_f32 v[62:63], v[170:171], v[170:171]
  v_pk_mul_f32 v[64:65], v[172:173], v[172:173]
  v_pk_mul_f32 v[66:67], v[174:175], v[174:175]
  v_pk_fma_f32 v[60:61], v[60:61], v[76:77], v[74:75]
  v_pk_fma_f32 v[62:63], v[62:63], v[76:77], v[74:75]
  v_pk_fma_f32 v[64:65], v[64:65], v[76:77], v[74:75]
  v_pk_fma_f32 v[66:67], v[66:67], v[76:77], v[74:75]
  v_pk_mul_f32 v[60:61], v[60:61], v[168:169]
  v_pk_mul_f32 v[62:63], v[62:63], v[170:171]
  v_pk_mul_f32 v[64:65], v[64:65], v[172:173]
  v_pk_mul_f32 v[66:67], v[66:67], v[174:175]
  v_exp_f32 v60, v60
  v_exp_f32 v61, v61
  v_exp_f32 v62, v62
  v_exp_f32 v63, v63
  v_exp_f32 v64, v64
  v_exp_f32 v65, v65
  v_exp_f32 v66, v66
  v_exp_f32 v67, v67
  v_pk_mul_f32 v[168:169], v[168:169], v[176:177]
  v_pk_mul_f32 v[170:171], v[170:171], v[178:179]
  v_pk_mul_f32 v[172:173], v[172:173], v[180:181]
  v_pk_mul_f32 v[174:175], v[174:175], v[182:183]
  v_pk_fma_f32 v[60:61], v[60:61], v[78:79], v[78:79]
  v_pk_fma_f32 v[62:63], v[62:63], v[78:79], v[78:79]
  v_pk_fma_f32 v[64:65], v[64:65], v[78:79], v[78:79]
  v_pk_fma_f32 v[66:67], v[66:67], v[78:79], v[78:79]
  v_rcp_f32 v60, v60
  v_rcp_f32 v61, v61
  v_rcp_f32 v62, v62
  v_rcp_f32 v63, v63
  v_rcp_f32 v64, v64
  v_rcp_f32 v65, v65
  v_rcp_f32 v66, v66
  v_rcp_f32_e64 v67, v67
  s_nop 0
  v_pk_mul_f32 v[168:169], v[168:169], v[60:61]
  v_pk_mul_f32 v[170:171], v[170:171], v[62:63]
  v_pk_mul_f32 v[172:173], v[172:173], v[64:65]
  v_pk_mul_f32 v[174:175], v[174:175], v[66:67]
  v_cvt_pk_bf16_f32 v176, v168, v169
  v_cvt_pk_bf16_f32 v177, v170, v171
  v_cvt_pk_bf16_f32 v178, v172, v173
  v_cvt_pk_bf16_f32 v179, v174, v175
  s_waitcnt vmcnt(0)
  s_mov_b64 exec, 1
  buffer_store_dword v9, v8, s[20:23], s72 offen offset:0 sc1
  s_mov_b64 exec, -1
  s_nop 0
  s_add_u32 s63, s70, 6144
  buffer_store_dwordx4 v[192:195], v2, s[20:23], s63 offen sc1
  s_add_u32 s63, s70, 120832
  buffer_store_dwordx4 v[208:211], v2, s[20:23], s63 offen sc1
  s_add_u32 s63, s70, 4096
  buffer_store_dwordx4 v[160:163], v2, s[20:23], s63 offen sc1
  s_add_u32 s63, s70, 118784
  buffer_store_dwordx4 v[176:179], v2, s[20:23], s63 offen sc1
  v_pk_mul_f32 v[60:61], v[120:121], v[120:121]
  v_pk_mul_f32 v[62:63], v[122:123], v[122:123]
  v_pk_mul_f32 v[64:65], v[124:125], v[124:125]
  v_pk_mul_f32 v[66:67], v[126:127], v[126:127]
  v_pk_fma_f32 v[60:61], v[60:61], v[70:71], v[68:69]
  v_pk_fma_f32 v[62:63], v[62:63], v[70:71], v[68:69]
  v_pk_fma_f32 v[64:65], v[64:65], v[70:71], v[68:69]
  v_pk_fma_f32 v[66:67], v[66:67], v[70:71], v[68:69]
  v_pk_mul_f32 v[60:61], v[60:61], v[120:121]
  v_pk_mul_f32 v[62:63], v[62:63], v[122:123]
  v_pk_mul_f32 v[64:65], v[64:65], v[124:125]
  v_pk_mul_f32 v[66:67], v[66:67], v[126:127]
  v_exp_f32 v60, v60
  v_exp_f32 v61, v61
  v_exp_f32 v62, v62
  v_exp_f32 v63, v63
  v_exp_f32 v64, v64
  v_exp_f32 v65, v65
  v_exp_f32 v66, v66
  v_exp_f32 v67, v67
  v_pk_mul_f32 v[120:121], v[120:121], v[128:129]
  v_pk_mul_f32 v[122:123], v[122:123], v[130:131]
  v_pk_mul_f32 v[124:125], v[124:125], v[132:133]
  v_pk_mul_f32 v[126:127], v[126:127], v[134:135]
  v_pk_fma_f32 v[60:61], v[60:61], v[72:73], v[72:73]
  v_pk_fma_f32 v[62:63], v[62:63], v[72:73], v[72:73]
  v_pk_fma_f32 v[64:65], v[64:65], v[72:73], v[72:73]
  v_pk_fma_f32 v[66:67], v[66:67], v[72:73], v[72:73]
  v_rcp_f32 v60, v60
  v_rcp_f32 v61, v61
  v_rcp_f32 v62, v62
  v_rcp_f32 v63, v63
  v_rcp_f32 v64, v64
  v_rcp_f32 v65, v65
  v_rcp_f32 v66, v66
  v_rcp_f32_e64 v67, v67
  s_nop 0
  v_pk_mul_f32 v[120:121], v[120:121], v[60:61]
  v_pk_mul_f32 v[122:123], v[122:123], v[62:63]
  v_pk_mul_f32 v[124:125], v[124:125], v[64:65]
  v_pk_mul_f32 v[126:127], v[126:127], v[66:67]
  v_cvt_pk_bf16_f32 v128, v120, v121
  v_cvt_pk_bf16_f32 v129, v122, v123
  v_cvt_pk_bf16_f32 v130, v124, v125
  v_cvt_pk_bf16_f32 v131, v126, v127
  s_add_u32 s63, s70, 2048
  buffer_store_dwordx4 v[128:131], v2, s[20:23], s63 offen sc1
  v_pk_mul_f32 v[60:61], v[136:137], v[136:137]
  v_pk_mul_f32 v[62:63], v[138:139], v[138:139]
  v_pk_mul_f32 v[64:65], v[140:141], v[140:141]
  v_pk_mul_f32 v[66:67], v[142:143], v[142:143]
  v_pk_fma_f32 v[60:61], v[60:61], v[76:77], v[74:75]
  v_pk_fma_f32 v[62:63], v[62:63], v[76:77], v[74:75]
  v_pk_fma_f32 v[64:65], v[64:65], v[76:77], v[74:75]
  v_pk_fma_f32 v[66:67], v[66:67], v[76:77], v[74:75]
  v_pk_mul_f32 v[60:61], v[60:61], v[136:137]
  v_pk_mul_f32 v[62:63], v[62:63], v[138:139]
  v_pk_mul_f32 v[64:65], v[64:65], v[140:141]
  v_pk_mul_f32 v[66:67], v[66:67], v[142:143]
  v_exp_f32 v60, v60
  v_exp_f32 v61, v61
  v_exp_f32 v62, v62
  v_exp_f32 v63, v63
  v_exp_f32 v64, v64
  v_exp_f32 v65, v65
  v_exp_f32 v66, v66
  v_exp_f32 v67, v67
  v_pk_mul_f32 v[136:137], v[136:137], v[144:145]
  v_pk_mul_f32 v[138:139], v[138:139], v[146:147]
  v_pk_mul_f32 v[140:141], v[140:141], v[148:149]
  v_pk_mul_f32 v[142:143], v[142:143], v[150:151]
  v_pk_fma_f32 v[60:61], v[60:61], v[78:79], v[78:79]
  v_pk_fma_f32 v[62:63], v[62:63], v[78:79], v[78:79]
  v_pk_fma_f32 v[64:65], v[64:65], v[78:79], v[78:79]
  v_pk_fma_f32 v[66:67], v[66:67], v[78:79], v[78:79]
  v_rcp_f32 v60, v60
  v_rcp_f32 v61, v61
  v_rcp_f32 v62, v62
  v_rcp_f32 v63, v63
  v_rcp_f32 v64, v64
  v_rcp_f32 v65, v65
  v_rcp_f32 v66, v66
  v_rcp_f32_e64 v67, v67
  s_nop 0
  v_pk_mul_f32 v[136:137], v[136:137], v[60:61]
  v_pk_mul_f32 v[138:139], v[138:139], v[62:63]
  v_pk_mul_f32 v[140:141], v[140:141], v[64:65]
  v_pk_mul_f32 v[142:143], v[142:143], v[66:67]
  v_cvt_pk_bf16_f32 v144, v136, v137
  v_cvt_pk_bf16_f32 v145, v138, v139
  v_cvt_pk_bf16_f32 v146, v140, v141
  v_cvt_pk_bf16_f32 v147, v142, v143
  s_add_u32 s63, s70, 116736
  buffer_store_dwordx4 v[144:147], v2, s[20:23], s63 offen sc1
  v_pk_mul_f32 v[60:61], v[88:89], v[88:89]
  v_pk_mul_f32 v[62:63], v[90:91], v[90:91]
  v_pk_mul_f32 v[64:65], v[92:93], v[92:93]
  v_pk_mul_f32 v[66:67], v[94:95], v[94:95]
  v_pk_fma_f32 v[60:61], v[60:61], v[70:71], v[68:69]
  v_pk_fma_f32 v[62:63], v[62:63], v[70:71], v[68:69]
  v_pk_fma_f32 v[64:65], v[64:65], v[70:71], v[68:69]
  v_pk_fma_f32 v[66:67], v[66:67], v[70:71], v[68:69]
  v_pk_mul_f32 v[60:61], v[60:61], v[88:89]
  v_pk_mul_f32 v[62:63], v[62:63], v[90:91]
  v_pk_mul_f32 v[64:65], v[64:65], v[92:93]
  v_pk_mul_f32 v[66:67], v[66:67], v[94:95]
  v_exp_f32 v60, v60
  v_exp_f32 v61, v61
  v_exp_f32 v62, v62
  v_exp_f32 v63, v63
  v_exp_f32 v64, v64
  v_exp_f32 v65, v65
  v_exp_f32 v66, v66
  v_exp_f32 v67, v67
  v_pk_mul_f32 v[88:89], v[88:89], v[96:97]
  v_pk_mul_f32 v[90:91], v[90:91], v[98:99]
  v_pk_mul_f32 v[92:93], v[92:93], v[100:101]
  v_pk_mul_f32 v[94:95], v[94:95], v[102:103]
  v_pk_fma_f32 v[60:61], v[60:61], v[72:73], v[72:73]
  v_pk_fma_f32 v[62:63], v[62:63], v[72:73], v[72:73]
  v_pk_fma_f32 v[64:65], v[64:65], v[72:73], v[72:73]
  v_pk_fma_f32 v[66:67], v[66:67], v[72:73], v[72:73]
  v_rcp_f32 v60, v60
  v_rcp_f32 v61, v61
  v_rcp_f32 v62, v62
  v_rcp_f32 v63, v63
  v_rcp_f32 v64, v64
  v_rcp_f32 v65, v65
  v_rcp_f32 v66, v66
  v_rcp_f32_e64 v67, v67
  s_nop 0
  v_pk_mul_f32 v[88:89], v[88:89], v[60:61]
  v_pk_mul_f32 v[90:91], v[90:91], v[62:63]
  v_pk_mul_f32 v[92:93], v[92:93], v[64:65]
  v_pk_mul_f32 v[94:95], v[94:95], v[66:67]
  v_cvt_pk_bf16_f32 v96, v88, v89
  v_cvt_pk_bf16_f32 v97, v90, v91
  v_cvt_pk_bf16_f32 v98, v92, v93
  v_cvt_pk_bf16_f32 v99, v94, v95
  s_add_u32 s63, s70, 0
  buffer_store_dwordx4 v[96:99], v2, s[20:23], s63 offen sc1
  s_nop 0
  v_pk_mul_f32 v[60:61], v[104:105], v[104:105]
  v_pk_mul_f32 v[62:63], v[106:107], v[106:107]
  v_pk_mul_f32 v[64:65], v[108:109], v[108:109]
  v_pk_mul_f32 v[66:67], v[110:111], v[110:111]
  v_pk_fma_f32 v[60:61], v[60:61], v[76:77], v[74:75]
  v_pk_fma_f32 v[62:63], v[62:63], v[76:77], v[74:75]
  v_pk_fma_f32 v[64:65], v[64:65], v[76:77], v[74:75]
  v_pk_fma_f32 v[66:67], v[66:67], v[76:77], v[74:75]
  v_pk_mul_f32 v[60:61], v[60:61], v[104:105]
  v_pk_mul_f32 v[62:63], v[62:63], v[106:107]
  v_pk_mul_f32 v[64:65], v[64:65], v[108:109]
  v_pk_mul_f32 v[66:67], v[66:67], v[110:111]
  v_exp_f32 v60, v60
  v_exp_f32 v61, v61
  v_exp_f32 v62, v62
  v_exp_f32 v63, v63
  v_exp_f32 v64, v64
  v_exp_f32 v65, v65
  v_exp_f32 v66, v66
  v_exp_f32 v67, v67
  v_pk_mul_f32 v[104:105], v[104:105], v[112:113]
  v_pk_mul_f32 v[106:107], v[106:107], v[114:115]
  v_pk_mul_f32 v[108:109], v[108:109], v[116:117]
  v_pk_mul_f32 v[110:111], v[110:111], v[118:119]
  v_pk_fma_f32 v[60:61], v[60:61], v[78:79], v[78:79]
  v_pk_fma_f32 v[62:63], v[62:63], v[78:79], v[78:79]
  v_pk_fma_f32 v[64:65], v[64:65], v[78:79], v[78:79]
  v_pk_fma_f32 v[66:67], v[66:67], v[78:79], v[78:79]
  v_rcp_f32 v60, v60
  v_rcp_f32 v61, v61
  v_rcp_f32 v62, v62
  v_rcp_f32 v63, v63
  v_rcp_f32 v64, v64
  v_rcp_f32 v65, v65
  v_rcp_f32 v66, v66
  v_rcp_f32_e64 v67, v67
  s_nop 0
  v_pk_mul_f32 v[104:105], v[104:105], v[60:61]
  v_pk_mul_f32 v[106:107], v[106:107], v[62:63]
  v_pk_mul_f32 v[108:109], v[108:109], v[64:65]
  v_pk_mul_f32 v[110:111], v[110:111], v[66:67]
  v_cvt_pk_bf16_f32 v112, v104, v105
  v_cvt_pk_bf16_f32 v113, v106, v107
  v_cvt_pk_bf16_f32 v114, v108, v109
  v_cvt_pk_bf16_f32 v115, v110, v111
  s_add_u32 s63, s70, 114688
  buffer_store_dwordx4 v[112:115], v2, s[20:23], s63 offen sc1
  s_branch M_TJ
M_TC:
  s_add_u32 s60, s54, 2
  s_cmp_lt_u32 s60, 8
  s_mov_b32 s62, 0x3eb8aa3b
  s_cselect_b32 s62, s62, 1.0
  v_mul_f32 v4, s62, v248
  v_mul_f32 v6, s62, v252
  v_mul_f32 v5, s62, v248
  v_mul_f32 v7, s62, v252
  v_pk_mul_f32 v[216:217], v[216:217], v[4:5]
  v_pk_mul_f32 v[218:219], v[218:219], v[4:5]
  v_pk_mul_f32 v[220:221], v[220:221], v[4:5]
  v_pk_mul_f32 v[222:223], v[222:223], v[4:5]
  v_pk_mul_f32 v[224:225], v[224:225], v[4:5]
  v_pk_mul_f32 v[226:227], v[226:227], v[4:5]
  v_pk_mul_f32 v[228:229], v[228:229], v[4:5]
  v_pk_mul_f32 v[230:231], v[230:231], v[4:5]
  v_cvt_pk_bf16_f32 v216, v216, v217
  v_cvt_pk_bf16_f32 v217, v218, v219
  v_cvt_pk_bf16_f32 v218, v220, v221
  v_cvt_pk_bf16_f32 v219, v222, v223
  v_cvt_pk_bf16_f32 v220, v224, v225
  v_cvt_pk_bf16_f32 v221, v226, v227
  v_cvt_pk_bf16_f32 v222, v228, v229
  v_cvt_pk_bf16_f32 v223, v230, v231
  s_add_u32 s63, s71, 524288
  buffer_store_dwordx4 v[216:219], v2, s[20:23], s63 offen sc1
  s_add_u32 s63, s63, 65536
  buffer_store_dwordx4 v[220:223], v2, s[20:23], s63 offen sc1
  v_pk_mul_f32 v[232:233], v[232:233], v[6:7]
  v_pk_mul_f32 v[234:235], v[234:235], v[6:7]
  v_pk_mul_f32 v[236:237], v[236:237], v[6:7]
  v_pk_mul_f32 v[238:239], v[238:239], v[6:7]
  v_pk_mul_f32 v[240:241], v[240:241], v[6:7]
  v_pk_mul_f32 v[242:243], v[242:243], v[6:7]
  v_pk_mul_f32 v[244:245], v[244:245], v[6:7]
  v_pk_mul_f32 v[246:247], v[246:247], v[6:7]
  v_cvt_pk_bf16_f32 v232, v232, v233
  v_cvt_pk_bf16_f32 v233, v234, v235
  v_cvt_pk_bf16_f32 v234, v236, v237
  v_cvt_pk_bf16_f32 v235, v238, v239
  v_cvt_pk_bf16_f32 v236, v240, v241
  v_cvt_pk_bf16_f32 v237, v242, v243
  v_cvt_pk_bf16_f32 v238, v244, v245
  v_cvt_pk_bf16_f32 v239, v246, v247
  s_add_u32 s63, s71, 525312
  buffer_store_dwordx4 v[232:235], v2, s[20:23], s63 offen sc1
  s_add_u32 s63, s63, 65536
  buffer_store_dwordx4 v[236:239], v2, s[20:23], s63 offen sc1
  s_add_u32 s60, s54, 1
  s_cmp_lt_u32 s60, 8
  s_mov_b32 s62, 0x3eb8aa3b
  s_cselect_b32 s62, s62, 1.0
  v_mul_f32 v4, s62, v248
  v_mul_f32 v6, s62, v252
  v_mul_f32 v5, s62, v248
  v_mul_f32_e64 v7, s62, v252
  v_pk_mul_f32 v[184:185], v[184:185], v[4:5]
  v_pk_mul_f32 v[186:187], v[186:187], v[4:5]
  v_pk_mul_f32 v[188:189], v[188:189], v[4:5]
  v_pk_mul_f32 v[190:191], v[190:191], v[4:5]
  v_pk_mul_f32 v[192:193], v[192:193], v[4:5]
  v_pk_mul_f32 v[194:195], v[194:195], v[4:5]
  v_pk_mul_f32 v[196:197], v[196:197], v[4:5]
  v_pk_mul_f32 v[198:199], v[198:199], v[4:5]
  v_cvt_pk_bf16_f32 v184, v184, v185
  v_cvt_pk_bf16_f32 v185, v186, v187
  v_cvt_pk_bf16_f32 v186, v188, v189
  v_cvt_pk_bf16_f32 v187, v190, v191
  v_cvt_pk_bf16_f32 v188, v192, v193
  v_cvt_pk_bf16_f32 v189, v194, v195
  v_cvt_pk_bf16_f32 v190, v196, v197
  v_cvt_pk_bf16_f32 v191, v198, v199
  s_add_u32 s63, s71, 262144
  buffer_store_dwordx4 v[184:187], v2, s[20:23], s63 offen sc1
  s_add_u32 s63, s63, 65536
  buffer_store_dwordx4 v[188:191], v2, s[20:23], s63 offen sc1
  v_pk_mul_f32 v[200:201], v[200:201], v[6:7]
  v_pk_mul_f32 v[202:203], v[202:203], v[6:7]
  v_pk_mul_f32 v[204:205], v[204:205], v[6:7]
  v_pk_mul_f32 v[206:207], v[206:207], v[6:7]
  v_pk_mul_f32 v[208:209], v[208:209], v[6:7]
  v_pk_mul_f32 v[210:211], v[210:211], v[6:7]
  v_pk_mul_f32 v[212:213], v[212:213], v[6:7]
  v_pk_mul_f32 v[214:215], v[214:215], v[6:7]
  v_cvt_pk_bf16_f32 v200, v200, v201
  v_cvt_pk_bf16_f32 v201, v202, v203
  v_cvt_pk_bf16_f32 v202, v204, v205
  v_cvt_pk_bf16_f32 v203, v206, v207
  v_cvt_pk_bf16_f32 v204, v208, v209
  v_cvt_pk_bf16_f32 v205, v210, v211
  v_cvt_pk_bf16_f32 v206, v212, v213
  v_cvt_pk_bf16_f32 v207, v214, v215
  s_add_u32 s63, s71, 263168
  buffer_store_dwordx4 v[200:203], v2, s[20:23], s63 offen sc1
  s_add_u32 s63, s63, 65536
  buffer_store_dwordx4 v[204:207], v2, s[20:23], s63 offen sc1
  s_add_u32 s60, s54, 0
  s_cmp_lt_u32 s60, 8
  s_mov_b32 s62, 0x3eb8aa3b
  s_cselect_b32 s62, s62, 1.0
  v_mul_f32 v4, s62, v248
  v_mul_f32 v6, s62, v252
  v_mul_f32 v5, s62, v248
  v_mul_f32_e64 v7, s62, v252
  v_pk_mul_f32 v[152:153], v[152:153], v[4:5]
  v_pk_mul_f32 v[154:155], v[154:155], v[4:5]
  v_pk_mul_f32 v[156:157], v[156:157], v[4:5]
  v_pk_mul_f32 v[158:159], v[158:159], v[4:5]
  v_pk_mul_f32 v[160:161], v[160:161], v[4:5]
  v_pk_mul_f32 v[162:163], v[162:163], v[4:5]
  v_pk_mul_f32 v[164:165], v[164:165], v[4:5]
  v_pk_mul_f32 v[166:167], v[166:167], v[4:5]
  v_cvt_pk_bf16_f32 v152, v152, v153
  v_cvt_pk_bf16_f32 v153, v154, v155
  v_cvt_pk_bf16_f32 v154, v156, v157
  v_cvt_pk_bf16_f32 v155, v158, v159
  v_cvt_pk_bf16_f32 v156, v160, v161
  v_cvt_pk_bf16_f32 v157, v162, v163
  v_cvt_pk_bf16_f32 v158, v164, v165
  v_cvt_pk_bf16_f32 v159, v166, v167
  s_add_u32 s63, s71, 0
  buffer_store_dwordx4 v[152:155], v2, s[20:23], s63 offen sc1
  s_nop 0
  s_add_u32 s63, s63, 65536
  buffer_store_dwordx4 v[156:159], v2, s[20:23], s63 offen sc1
  v_pk_mul_f32 v[168:169], v[168:169], v[6:7]
  v_pk_mul_f32 v[170:171], v[170:171], v[6:7]
  v_pk_mul_f32 v[172:173], v[172:173], v[6:7]
  v_pk_mul_f32 v[174:175], v[174:175], v[6:7]
  v_pk_mul_f32 v[176:177], v[176:177], v[6:7]
  v_pk_mul_f32 v[178:179], v[178:179], v[6:7]
  v_pk_mul_f32 v[180:181], v[180:181], v[6:7]
  v_pk_mul_f32 v[182:183], v[182:183], v[6:7]
  v_cvt_pk_bf16_f32 v168, v168, v169
  v_cvt_pk_bf16_f32 v169, v170, v171
  v_cvt_pk_bf16_f32 v170, v172, v173
  v_cvt_pk_bf16_f32 v171, v174, v175
  v_cvt_pk_bf16_f32 v172, v176, v177
  v_cvt_pk_bf16_f32 v173, v178, v179
  v_cvt_pk_bf16_f32 v174, v180, v181
  v_cvt_pk_bf16_f32 v175, v182, v183
  s_add_u32 s63, s71, 1024
  buffer_store_dwordx4 v[168:171], v2, s[20:23], s63 offen sc1
  s_add_u32 s63, s63, 65536
  buffer_store_dwordx4 v[172:175], v2, s[20:23], s63 offen sc1
  s_barrier
  s_nop 0
  v_pk_mul_f32 v[60:61], v[120:121], v[120:121]
  v_pk_mul_f32 v[62:63], v[122:123], v[122:123]
  v_pk_mul_f32 v[64:65], v[124:125], v[124:125]
  v_pk_mul_f32 v[66:67], v[126:127], v[126:127]
  v_pk_fma_f32 v[60:61], v[60:61], v[70:71], v[68:69]
  v_pk_fma_f32 v[62:63], v[62:63], v[70:71], v[68:69]
  v_pk_fma_f32 v[64:65], v[64:65], v[70:71], v[68:69]
  v_pk_fma_f32 v[66:67], v[66:67], v[70:71], v[68:69]
  v_pk_mul_f32 v[60:61], v[60:61], v[120:121]
  v_pk_mul_f32 v[62:63], v[62:63], v[122:123]
  v_pk_mul_f32 v[64:65], v[64:65], v[124:125]
  v_pk_mul_f32 v[66:67], v[66:67], v[126:127]
  v_exp_f32 v60, v60
  v_exp_f32 v61, v61
  v_exp_f32 v62, v62
  v_exp_f32 v63, v63
  v_exp_f32 v64, v64
  v_exp_f32 v65, v65
  v_exp_f32 v66, v66
  v_exp_f32 v67, v67
  v_pk_mul_f32 v[120:121], v[120:121], v[128:129]
  v_pk_mul_f32 v[122:123], v[122:123], v[130:131]
  v_pk_mul_f32 v[124:125], v[124:125], v[132:133]
  v_pk_mul_f32 v[126:127], v[126:127], v[134:135]
  v_pk_fma_f32 v[60:61], v[60:61], v[72:73], v[72:73]
  v_pk_fma_f32 v[62:63], v[62:63], v[72:73], v[72:73]
  v_pk_fma_f32 v[64:65], v[64:65], v[72:73], v[72:73]
  v_pk_fma_f32 v[66:67], v[66:67], v[72:73], v[72:73]
  v_rcp_f32 v60, v60
  v_rcp_f32 v61, v61
  v_rcp_f32 v62, v62
  v_rcp_f32 v63, v63
  v_rcp_f32 v64, v64
  v_rcp_f32 v65, v65
  v_rcp_f32 v66, v66
  v_rcp_f32_e64 v67, v67
  s_nop 0
  v_pk_mul_f32 v[120:121], v[120:121], v[60:61]
  v_pk_mul_f32 v[122:123], v[122:123], v[62:63]
  v_pk_mul_f32 v[124:125], v[124:125], v[64:65]
  v_pk_mul_f32 v[126:127], v[126:127], v[66:67]
  v_cvt_pk_bf16_f32 v128, v120, v121
  v_cvt_pk_bf16_f32 v129, v122, v123
  v_cvt_pk_bf16_f32 v130, v124, v125
  v_cvt_pk_bf16_f32 v131, v126, v127
  v_pk_mul_f32 v[60:61], v[136:137], v[136:137]
  v_pk_mul_f32 v[62:63], v[138:139], v[138:139]
  v_pk_mul_f32 v[64:65], v[140:141], v[140:141]
  v_pk_mul_f32 v[66:67], v[142:143], v[142:143]
  v_pk_fma_f32 v[60:61], v[60:61], v[76:77], v[74:75]
  v_pk_fma_f32 v[62:63], v[62:63], v[76:77], v[74:75]
  v_pk_fma_f32 v[64:65], v[64:65], v[76:77], v[74:75]
  v_pk_fma_f32 v[66:67], v[66:67], v[76:77], v[74:75]
  v_pk_mul_f32 v[60:61], v[60:61], v[136:137]
  v_pk_mul_f32 v[62:63], v[62:63], v[138:139]
  v_pk_mul_f32 v[64:65], v[64:65], v[140:141]
  v_pk_mul_f32 v[66:67], v[66:67], v[142:143]
  v_exp_f32 v60, v60
  v_exp_f32 v61, v61
  v_exp_f32 v62, v62
  v_exp_f32 v63, v63
  v_exp_f32 v64, v64
  v_exp_f32 v65, v65
  v_exp_f32 v66, v66
  v_exp_f32 v67, v67
  v_pk_mul_f32 v[136:137], v[136:137], v[144:145]
  v_pk_mul_f32 v[138:139], v[138:139], v[146:147]
  v_pk_mul_f32 v[140:141], v[140:141], v[148:149]
  v_pk_mul_f32 v[142:143], v[142:143], v[150:151]
  v_pk_fma_f32 v[60:61], v[60:61], v[78:79], v[78:79]
  v_pk_fma_f32 v[62:63], v[62:63], v[78:79], v[78:79]
  v_pk_fma_f32 v[64:65], v[64:65], v[78:79], v[78:79]
  v_pk_fma_f32 v[66:67], v[66:67], v[78:79], v[78:79]
  v_rcp_f32 v60, v60
  v_rcp_f32 v61, v61
  v_rcp_f32 v62, v62
  v_rcp_f32 v63, v63
  v_rcp_f32 v64, v64
  v_rcp_f32 v65, v65
  v_rcp_f32 v66, v66
  v_rcp_f32_e64 v67, v67
  s_nop 0
  v_pk_mul_f32 v[136:137], v[136:137], v[60:61]
  v_pk_mul_f32 v[138:139], v[138:139], v[62:63]
  v_pk_mul_f32 v[140:141], v[140:141], v[64:65]
  v_pk_mul_f32 v[142:143], v[142:143], v[66:67]
  v_cvt_pk_bf16_f32 v144, v136, v137
  v_cvt_pk_bf16_f32 v145, v138, v139
  v_cvt_pk_bf16_f32 v146, v140, v141
  v_cvt_pk_bf16_f32 v147, v142, v143
  s_waitcnt vmcnt(0)
  s_mov_b64 exec, 7
  buffer_store_dword v9, v8, s[20:23], s72 offen offset:0 sc1
  s_mov_b64 exec, -1
  s_nop 0
  v_pk_mul_f32 v[60:61], v[88:89], v[88:89]
  v_pk_mul_f32 v[62:63], v[90:91], v[90:91]
  v_pk_mul_f32 v[64:65], v[92:93], v[92:93]
  v_pk_mul_f32 v[66:67], v[94:95], v[94:95]
  v_pk_fma_f32 v[60:61], v[60:61], v[70:71], v[68:69]
  v_pk_fma_f32 v[62:63], v[62:63], v[70:71], v[68:69]
  v_pk_fma_f32 v[64:65], v[64:65], v[70:71], v[68:69]
  v_pk_fma_f32 v[66:67], v[66:67], v[70:71], v[68:69]
  v_pk_mul_f32 v[60:61], v[60:61], v[88:89]
  v_pk_mul_f32 v[62:63], v[62:63], v[90:91]
  v_pk_mul_f32 v[64:65], v[64:65], v[92:93]
  v_pk_mul_f32 v[66:67], v[66:67], v[94:95]
  v_exp_f32 v60, v60
  v_exp_f32 v61, v61
  v_exp_f32 v62, v62
  v_exp_f32 v63, v63
  v_exp_f32 v64, v64
  v_exp_f32 v65, v65
  v_exp_f32 v66, v66
  v_exp_f32 v67, v67
  v_pk_mul_f32 v[88:89], v[88:89], v[96:97]
  v_pk_mul_f32 v[90:91], v[90:91], v[98:99]
  v_pk_mul_f32 v[92:93], v[92:93], v[100:101]
  v_pk_mul_f32 v[94:95], v[94:95], v[102:103]
  v_pk_fma_f32 v[60:61], v[60:61], v[72:73], v[72:73]
  v_pk_fma_f32 v[62:63], v[62:63], v[72:73], v[72:73]
  v_pk_fma_f32 v[64:65], v[64:65], v[72:73], v[72:73]
  v_pk_fma_f32 v[66:67], v[66:67], v[72:73], v[72:73]
  v_rcp_f32 v60, v60
  v_rcp_f32 v61, v61
  v_rcp_f32 v62, v62
  v_rcp_f32 v63, v63
  v_rcp_f32 v64, v64
  v_rcp_f32 v65, v65
  v_rcp_f32 v66, v66
  v_rcp_f32_e64 v67, v67
  s_nop 0
  v_pk_mul_f32 v[88:89], v[88:89], v[60:61]
  v_pk_mul_f32 v[90:91], v[90:91], v[62:63]
  v_pk_mul_f32 v[92:93], v[92:93], v[64:65]
  v_pk_mul_f32 v[94:95], v[94:95], v[66:67]
  v_cvt_pk_bf16_f32 v96, v88, v89
  v_cvt_pk_bf16_f32 v97, v90, v91
  v_cvt_pk_bf16_f32 v98, v92, v93
  v_cvt_pk_bf16_f32 v99, v94, v95
  v_pk_mul_f32 v[60:61], v[104:105], v[104:105]
  v_pk_mul_f32 v[62:63], v[106:107], v[106:107]
  v_pk_mul_f32 v[64:65], v[108:109], v[108:109]
  v_pk_mul_f32 v[66:67], v[110:111], v[110:111]
  v_pk_fma_f32 v[60:61], v[60:61], v[76:77], v[74:75]
  v_pk_fma_f32 v[62:63], v[62:63], v[76:77], v[74:75]
  v_pk_fma_f32 v[64:65], v[64:65], v[76:77], v[74:75]
  v_pk_fma_f32 v[66:67], v[66:67], v[76:77], v[74:75]
  v_pk_mul_f32 v[60:61], v[60:61], v[104:105]
  v_pk_mul_f32 v[62:63], v[62:63], v[106:107]
  v_pk_mul_f32 v[64:65], v[64:65], v[108:109]
  v_pk_mul_f32 v[66:67], v[66:67], v[110:111]
  v_exp_f32 v60, v60
  v_exp_f32 v61, v61
  v_exp_f32 v62, v62
  v_exp_f32 v63, v63
  v_exp_f32 v64, v64
  v_exp_f32 v65, v65
  v_exp_f32 v66, v66
  v_exp_f32 v67, v67
  v_pk_mul_f32 v[104:105], v[104:105], v[112:113]
  v_pk_mul_f32 v[106:107], v[106:107], v[114:115]
  v_pk_mul_f32 v[108:109], v[108:109], v[116:117]
  v_pk_mul_f32 v[110:111], v[110:111], v[118:119]
  v_pk_fma_f32 v[60:61], v[60:61], v[78:79], v[78:79]
  v_pk_fma_f32 v[62:63], v[62:63], v[78:79], v[78:79]
  v_pk_fma_f32 v[64:65], v[64:65], v[78:79], v[78:79]
  v_pk_fma_f32 v[66:67], v[66:67], v[78:79], v[78:79]
  v_rcp_f32 v60, v60
  v_rcp_f32 v61, v61
  v_rcp_f32 v62, v62
  v_rcp_f32 v63, v63
  v_rcp_f32 v64, v64
  v_rcp_f32 v65, v65
  v_rcp_f32 v66, v66
  v_rcp_f32_e64 v67, v67
  s_nop 0
  v_pk_mul_f32 v[104:105], v[104:105], v[60:61]
  v_pk_mul_f32 v[106:107], v[106:107], v[62:63]
  v_pk_mul_f32 v[108:109], v[108:109], v[64:65]
  v_pk_mul_f32 v[110:111], v[110:111], v[66:67]
  v_cvt_pk_bf16_f32 v112, v104, v105
  v_cvt_pk_bf16_f32 v113, v106, v107
  v_cvt_pk_bf16_f32 v114, v108, v109
  v_cvt_pk_bf16_f32 v115, v110, v111
  s_add_u32 s63, s70, 2048
  buffer_store_dwordx4 v[128:131], v2, s[20:23], s63 offen sc1
  s_add_u32 s63, s70, 116736
  buffer_store_dwordx4 v[144:147], v2, s[20:23], s63 offen sc1
  s_add_u32 s63, s70, 0
  buffer_store_dwordx4 v[96:99], v2, s[20:23], s63 offen sc1
  s_add_u32 s63, s70, 114688
  buffer_store_dwordx4 v[112:115], v2, s[20:23], s63 offen sc1
M_TJ:
  s_mov_b32 s15, s14
  v_bfe_u32 v6, v1, 2, 3
  v_lshlrev_b32 v6, 10, v6
  v_lshrrev_b32 v7, 5, v1
  v_lshlrev_b32 v7, 6, v7
  v_add_u32 v6, v6, v7
  v_and_b32 v7, 3, v1
  v_lshlrev_b32 v7, 4, v7
  v_add_u32 v2, v6, v7
  s_lshl_b32 s43, s15, 11
  s_lshr_b32 s58, s2, 5
  s_lshl_b32 s40, s58, 7
  s_lshl_b32 s42, s15, 17
  s_add_u32 s42, s42, s40
  s_mul_i32 s57, s15, 24
  s_mul_i32 s59, s58, 11
  s_lshr_b32 s59, s59, 5
  s_mul_i32 s59, s59, 3
  s_sub_u32 s59, s58, s59
  s_lshl_b32 s60, s59, 3
  s_add_u32 s60, s60, s57
  s_add_u32 s60, s60, 4
  s_add_u32 s59, s59, 1
  s_cmp_eq_u32 s59, 3
  s_cselect_b32 s59, 0, s59
  s_lshl_b32 s61, s59, 3
  s_add_u32 s61, s61, s57
  s_add_u32 s61, s61, 4
  s_add_u32 s59, s59, 1
  s_cmp_eq_u32 s59, 3
  s_cselect_b32 s59, 0, s59
  s_lshl_b32 s62, s59, 3
  s_add_u32 s62, s62, s57
  s_add_u32 s62, s62, 4
  s_add_u32 s59, s59, 1
  s_cmp_eq_u32 s59, 3
  s_cselect_b32 s59, 0, s59
  s_lshl_b32 s41, s15, 2
  s_add_u32 s41, s41, 96
  s_add_u32 s59, s58, 0
  s_and_b32 s59, s59, 3
  s_lshl_b32 s44, s59, 3
  s_add_u32 s44, s44, s57
  s_cmp_eq_u32 s59, 3
  s_cselect_b32 s76, s41, s44
  s_add_u32 s59, s58, 1
  s_and_b32 s59, s59, 3
  s_lshl_b32 s44, s59, 3
  s_add_u32 s44, s44, s57
  s_cmp_eq_u32 s59, 3
  s_cselect_b32 s77, s41, s44
  s_add_u32 s59, s58, 2
  s_and_b32 s59, s59, 3
  s_lshl_b32 s44, s59, 3
  s_add_u32 s44, s44, s57
  s_cmp_eq_u32 s59, 3
  s_cselect_b32 s78, s41, s44
  s_add_u32 s59, s58, 3
  s_and_b32 s59, s59, 3
  s_lshl_b32 s44, s59, 3
  s_add_u32 s44, s44, s57
  s_cmp_eq_u32 s59, 3
  s_cselect_b32 s79, s41, s44
  s_waitcnt lgkmcnt(0)
  s_nop 0
  s_mov_b32 s26, 0x1c0000
  s_mov_b32 s27, 0x20000
  s_mov_b32 s30, 0x80000
  s_mov_b32 s31, 0x20000
  s_waitcnt vmcnt(0)
  s_mov_b64 exec, 1
  buffer_store_dword v9, v8, s[20:23], s74 offen offset:0 sc1
  s_mov_b64 exec, -1
  s_and_b32 s57, s2, 6
  s_lshl_b32 s50, s57, 1
  s_and_b32 s57, s2, 1
  s_lshl_b32 s57, s57, 4
  s_add_u32 s50, s50, s57
  s_lshr_b32 s57, s2, 3
  s_and_b32 s57, s57, 3
  s_add_u32 s50, s50, s57
  s_lshr_b32 s51, s2, 5
  v_lshlrev_b32 v3, 4, v1
  s_lshl_b32 s55, s50, 13
  s_lshl_b32 s57, s15, 10
  s_add_u32 s55, s55, s57
  s_add_u32 s55, s55, 18087936
  s_add_u32 s75, s55, 4096
  v_min_u32 v226, 5, v1
  v_lshlrev_b32 v226, 7, v226
  v_min_u32 v227, 7, v1
  v_lshlrev_b32_e64 v227, 7, v227
  s_sleep 16
  buffer_load_dword v228, v227, s[20:23], s75 offen sc1
  s_lshl_b32 s57, s50, 1
  s_and_b32 s58, s15, 1
  s_add_u32 s59, s57, s58
  s_xor_b32 s58, s58, 1
  s_add_u32 s57, s57, s58
  s_nop 0
  s_mul_i32 s64, s59, 114688
  s_add_u32 s64, s64, 8388608
  s_mul_i32 s65, s57, 114688
  s_add_u32 s65, s65, 8388608
  s_lshl_b32 s58, s15, 13
  s_add_u32 s58, s58, 6291456
  s_lshl_b32 s67, s59, 15
  s_add_u32 s67, s67, s58
  s_lshl_b32 s53, s57, 15
  s_add_u32 s53, s53, s58
  v_and_b32 v6, 31, v1
  v_lshlrev_b32 v6, 10, v6
  v_lshrrev_b32 v7, 5, v1
  v_lshlrev_b32 v7, 4, v7
  v_add_u32 v224, v6, v7
  s_lshl_b32 s54, s59, 15
  s_lshl_b32 s57, s51, 7
  s_add_u32 s54, s54, s57
  s_lshr_b32 s57, s15, 1
  s_lshl_b32 s57, s57, 6
  s_add_u32 s54, s54, s57
  v_lshrrev_b32 v6, 5, v1
  v_lshlrev_b32 v6, 8, v6
  v_bfe_u32 v7, v1, 2, 2
  v_lshlrev_b32 v7, 6, v7
  v_add_u32 v6, v6, v7
  v_and_b32 v7, 3, v1
  v_lshlrev_b32 v7, 3, v7
  v_add_u32_e64 v6, v6, v7
  v_bfe_u32 v7, v1, 4, 1
  v_lshlrev_b32 v7, 5, v7
  v_add_u32 v6, v6, v7
  s_lshl_b32 s57, s57, 3
  v_add_u32 v6, s57, v6
  v_xor_b32 v7, 512, v6
  v_add_u32 v4, s43, v6
  v_add_u32 v5, s43, v7
  v_add_u32 v232, 0x10000, v4
  v_add_u32 v233, 0x10000, v5
  v_add_u32 v234, 0x20000, v4
  v_add_u32 v235, 0x20000, v5
  s_mov_b32 s32, s4
  s_mov_b32 s33, s5
  s_mov_b32 s34, 0x200000
  s_mov_b32 s35, 0x20000
  s_mov_b32 s38, 0x200000
  s_mov_b32 s39, 0x20000
  s_setprio 0
  s_waitcnt vmcnt(0)
  v_cmp_eq_u32 vcc, s80, v228
  s_mov_b32 s56, 0
  s_cmp_eq_u64 vcc, -1
  s_cbranch_scc1 MH0_OK
MH0_P:
  s_sleep 8
  buffer_load_dword v228, v227, s[20:23], s75 offen sc1
  s_add_u32 s56, s56, 1
  s_waitcnt vmcnt(0)
  v_cmp_eq_u32 vcc, s80, v228
  s_cmp_gt_u32 s56, 20000
  s_cbranch_scc1 MH0_OK
  s_cmp_eq_u64 vcc, -1
  s_cbranch_scc0 MH0_P
MH0_OK:
  v_bfe_u32 v229, v1, 2, 2
  v_lshlrev_b32 v230, 13, v229
  s_mul_i32 s57, s15, 24576
  s_add_u32 s57, s57, 4096
  v_add_u32 v230, s57, v230
  s_lshl_b32 s58, s15, 12
  s_add_u32 s58, s58, 98304
  v_mov_b32 v231, s57
  v_cmp_eq_u32 vcc, 3, v229
  v_and_b32 v229, 3, v1
  v_lshlrev_b32 v229, 10, v229
  v_cndmask_b32 v230, v230, v231, vcc
  v_add_u32 v230, v230, v229
  v_bfe_u32 v229, v1, 4, 1
  v_mul_u32_u24 v229, 114688, v229
  v_add_u32_e64 v230, v230, v229
  s_min_u32 s57, s64, s65
  s_lshl_b32 s58, s51, 7
  s_add_u32 s57, s57, s58
  s_mov_b32 exec_hi, 0
  buffer_load_dword v248, v230, s[20:23], s57 offen sc1
  s_mov_b64 exec, -1
  s_lshl_b32 s48, s60, 10
  s_add_u32 s49, s48, s65
  s_add_u32 s48, s48, s64
  buffer_load_dwordx4 v[16:19], v3, s[20:23], s48 offen offset:0 sc1
  buffer_load_dwordx4 v[20:23], v3, s[20:23], s49 offen offset:0 sc1
  buffer_load_dwordx4 v[24:27], v3, s[20:23], s48 offen offset:1024 sc1
  buffer_load_dwordx4 v[28:31], v3, s[20:23], s49 offen offset:1024 sc1
  buffer_load_dwordx4 v[32:35], v3, s[20:23], s48 offen offset:2048 sc1
  buffer_load_dwordx4 v[36:39], v3, s[20:23], s49 offen offset:2048 sc1
  buffer_load_dwordx4 v[40:43], v3, s[20:23], s48 offen offset:3072 sc1
  buffer_load_dwordx4 v[44:47], v3, s[20:23], s49 offen offset:3072 sc1
  s_lshl_b32 s48, s61, 10
  s_add_u32 s49, s48, s65
  s_add_u32 s48, s48, s64
  buffer_load_dwordx4 v[48:51], v3, s[20:23], s48 offen offset:0 sc1
  buffer_load_dwordx4 v[52:55], v3, s[20:23], s49 offen offset:0 sc1
  buffer_load_dwordx4 v[56:59], v3, s[20:23], s48 offen offset:1024 sc1
  buffer_load_dwordx4 v[60:63], v3, s[20:23], s49 offen offset:1024 sc1
  buffer_load_dwordx4 v[64:67], v3, s[20:23], s48 offen offset:2048 sc1
  buffer_load_dwordx4 v[68:71], v3, s[20:23], s49 offen offset:2048 sc1
  ds_read_b64_tr_b16 v[80:81], v4 offset:32768
  ds_read_b64_tr_b16 v[82:83], v4 offset:33792
  ds_read_b64_tr_b16 v[84:85], v5 offset:32768
  ds_read_b64_tr_b16 v[86:87], v5 offset:33792
  s_waitcnt vmcnt(12)
  s_waitcnt vmcnt(10)
  ds_read_b64_tr_b16 v[88:89], v4 offset:40960
  ds_read_b64_tr_b16 v[90:91], v4 offset:41984
  ds_read_b64_tr_b16 v[92:93], v5 offset:40960
  ds_read_b64_tr_b16 v[94:95], v5 offset:41984
  s_waitcnt lgkmcnt(4)
  v_add_u32_e64 v236, s43, v3
  v_add_u32 v6, 0x10000, v236
  v_add_u32 v7, 0x20000, v236
  v_mfma_f32_32x32x16_bf16 v[96:111], v[80:83], v[16:19], 0
  v_mfma_f32_32x32x16_bf16 v[112:127], v[80:83], v[20:23], 0
  buffer_load_dwordx4 v[72:75], v3, s[20:23], s48 offen offset:3072 sc1
  v_mfma_f32_32x32x16_bf16 v[128:143], v[84:87], v[16:19], 0
  v_mfma_f32_32x32x16_bf16 v[144:159], v[84:87], v[20:23], 0
  buffer_load_dwordx4 v[76:79], v3, s[20:23], s49 offen offset:3072 sc1
  s_waitcnt vmcnt(10)
  ds_read_b64_tr_b16 v[80:81], v232 offset:4096
  ds_read_b64_tr_b16 v[82:83], v232 offset:5120
  ds_read_b64_tr_b16 v[84:85], v233 offset:4096
  ds_read_b64_tr_b16 v[86:87], v233 offset:5120
  s_waitcnt lgkmcnt(4)
  v_mfma_f32_32x32x16_bf16 v[96:111], v[88:91], v[24:27], v[96:111]
  s_lshl_b32 s48, s62, 10
  s_add_u32 s49, s48, s65
  s_add_u32 s48, s48, s64
  buffer_load_dwordx4 v[16:19], v3, s[20:23], s48 offen offset:0 sc1
  v_mfma_f32_32x32x16_bf16 v[112:127], v[88:91], v[28:31], v[112:127]
  buffer_load_dwordx4 v[20:23], v3, s[20:23], s49 offen offset:0 sc1
  v_mfma_f32_32x32x16_bf16 v[128:143], v[92:95], v[24:27], v[128:143]
  s_lshl_b32 s44, s76, 14
  s_add_u32 s44, s44, s40
  s_nop 0
  s_add_u32 s44, s44, 32768
  s_add_u32 m0, s43, 32768
  s_add_u32 s45, s44, 8192
  buffer_load_dwordx4 v2, s[24:27], s44 offen lds
  v_mfma_f32_32x32x16_bf16 v[144:159], v[92:95], v[28:31], v[144:159]
  s_add_u32 m0, s43, 33792
  s_nop 0
  buffer_load_dwordx4 v2, s[24:27], s45 offen lds
  s_waitcnt vmcnt(12)
  ds_read_b64_tr_b16 v[88:89], v232 offset:12288
  ds_read_b64_tr_b16 v[90:91], v232 offset:13312
  ds_read_b64_tr_b16 v[92:93], v233 offset:12288
  ds_read_b64_tr_b16 v[94:95], v233 offset:13312
  s_waitcnt lgkmcnt(4)
  v_mfma_f32_32x32x16_bf16 v[96:111], v[80:83], v[32:35], v[96:111]
  buffer_load_dwordx4 v[24:27], v3, s[20:23], s48 offen offset:1024 sc1
  v_mfma_f32_32x32x16_bf16 v[112:127], v[80:83], v[36:39], v[112:127]
  buffer_load_dwordx4 v[28:31], v3, s[20:23], s49 offen offset:1024 sc1
  v_mfma_f32_32x32x16_bf16 v[128:143], v[84:87], v[32:35], v[128:143]
  s_lshl_b32 s44, s76, 14
  s_add_u32 s44, s44, s40
  s_nop 0
  s_add_u32 s44, s44, 49152
  s_add_u32 m0, s43, 40960
  s_add_u32 s45, s44, 8192
  buffer_load_dwordx4 v2, s[24:27], s44 offen lds
  v_mfma_f32_32x32x16_bf16 v[144:159], v[84:87], v[36:39], v[144:159]
  s_add_u32 m0, s43, 41984
  s_nop 0
  buffer_load_dwordx4 v2, s[24:27], s45 offen lds
  s_waitcnt vmcnt(14)
  ds_read_b64_tr_b16 v[80:81], v232 offset:20480
  ds_read_b64_tr_b16 v[82:83], v232 offset:21504
  ds_read_b64_tr_b16 v[84:85], v233 offset:20480
  ds_read_b64_tr_b16 v[86:87], v233 offset:21504
  s_waitcnt lgkmcnt(4)
  v_bfe_u32 v229, v1, 2, 2
  v_lshlrev_b32 v230, 13, v229
  s_mul_i32 s57, s15, 24576
  s_add_u32 s57, s57, 0
  v_add_u32_e64 v230, s57, v230
  s_lshl_b32 s58, s15, 12
  s_add_u32 s58, s58, 98304
  v_mov_b32 v231, s58
  v_cmp_eq_u32 vcc, 3, v229
  v_and_b32 v229, 3, v1
  v_lshlrev_b32 v229, 10, v229
  v_cndmask_b32 v230, v230, v231, vcc
  v_add_u32 v230, v230, v229
  v_bfe_u32 v229, v1, 4, 1
  v_mul_u32_u24 v229, 114688, v229
  v_add_u32_e64 v230, v230, v229
  s_min_u32 s57, s64, s65
  s_lshl_b32 s58, s51, 7
  s_add_u32 s57, s57, s58
  s_mov_b32 exec_hi, 0
  buffer_load_dword v248, v230, s[20:23], s57 offen sc1
  s_mov_b64 exec, -1
  v_mfma_f32_32x32x16_bf16 v[96:111], v[88:91], v[40:43], v[96:111]
  buffer_load_dwordx4 v[32:35], v3, s[20:23], s48 offen offset:2048 sc1
  v_mfma_f32_32x32x16_bf16 v[112:127], v[88:91], v[44:47], v[112:127]
  buffer_load_dwordx4 v[36:39], v3, s[20:23], s49 offen offset:2048 sc1
  v_mfma_f32_32x32x16_bf16 v[128:143], v[92:95], v[40:43], v[128:143]
  s_lshl_b32 s44, s77, 14
  s_add_u32 s44, s44, s40
  s_nop 0
  s_add_u32 m0, s43, 69632
  s_add_u32 s45, s44, 8192
  buffer_load_dwordx4 v2, s[24:27], s44 offen lds
  v_mfma_f32_32x32x16_bf16 v[144:159], v[92:95], v[44:47], v[144:159]
  s_add_u32 m0, s43, 70656
  s_nop 0
  buffer_load_dwordx4 v2, s[24:27], s45 offen lds
  s_waitcnt vmcnt(17)
  ds_read_b64_tr_b16 v[88:89], v232 offset:28672
  ds_read_b64_tr_b16 v[90:91], v232 offset:29696
  ds_read_b64_tr_b16 v[92:93], v233 offset:28672
  ds_read_b64_tr_b16 v[94:95], v233 offset:29696
  s_waitcnt lgkmcnt(4)
  v_mfma_f32_32x32x16_bf16 v[96:111], v[80:83], v[48:51], v[96:111]
  buffer_load_dwordx4 v[40:43], v3, s[20:23], s48 offen offset:3072 sc1
  v_mfma_f32_32x32x16_bf16 v[112:127], v[80:83], v[52:55], v[112:127]
  buffer_load_dwordx4 v[44:47], v3, s[20:23], s49 offen offset:3072 sc1
  v_mfma_f32_32x32x16_bf16 v[128:143], v[84:87], v[48:51], v[128:143]
  s_lshl_b32 s44, s77, 14
  s_add_u32 s44, s44, s40
  s_nop 0
  s_add_u32 s44, s44, 16384
  s_add_u32 m0, s43, 77824
  s_add_u32 s45, s44, 8192
  buffer_load_dwordx4 v2, s[24:27], s44 offen lds
  v_mfma_f32_32x32x16_bf16 v[144:159], v[84:87], v[52:55], v[144:159]
  s_add_u32 m0, s43, 78848
  s_nop 0
  buffer_load_dwordx4 v2, s[24:27], s45 offen lds
  s_waitcnt vmcnt(19)
  ds_read_b64_tr_b16 v[80:81], v232 offset:36864
  ds_read_b64_tr_b16 v[82:83], v232 offset:37888
  ds_read_b64_tr_b16 v[84:85], v233 offset:36864
  ds_read_b64_tr_b16 v[86:87], v233 offset:37888
  s_waitcnt lgkmcnt(4)
  v_mfma_f32_32x32x16_bf16 v[96:111], v[88:91], v[56:59], v[96:111]
  s_lshl_b32 s48, s76, 10
  s_add_u32 s49, s48, s65
  s_add_u32 s48, s48, s64
  buffer_load_dwordx4 v[48:51], v3, s[20:23], s48 offen offset:0 sc1
  v_mfma_f32_32x32x16_bf16 v[112:127], v[88:91], v[60:63], v[112:127]
  buffer_load_dwordx4 v[52:55], v3, s[20:23], s49 offen offset:0 sc1
  v_mfma_f32_32x32x16_bf16 v[128:143], v[92:95], v[56:59], v[128:143]
  s_lshl_b32 s44, s77, 14
  s_add_u32 s44, s44, s40
  s_add_u32 s44, s44, 32768
  s_add_u32 m0, s43, 86016
  s_add_u32 s45, s44, 8192
  buffer_load_dwordx4 v2, s[24:27], s44 offen lds
  v_mfma_f32_32x32x16_bf16 v[144:159], v[92:95], v[60:63], v[144:159]
  s_add_u32 m0, s43, 87040
  s_nop 0
  buffer_load_dwordx4 v2, s[24:27], s45 offen lds
  s_waitcnt vmcnt(21)
  ds_read_b64_tr_b16 v[88:89], v232 offset:45056
  ds_read_b64_tr_b16 v[90:91], v232 offset:46080
  ds_read_b64_tr_b16 v[92:93], v233 offset:45056
  ds_read_b64_tr_b16 v[94:95], v233 offset:46080
  s_waitcnt lgkmcnt(4)
  v_mfma_f32_32x32x16_bf16 v[96:111], v[80:83], v[64:67], v[96:111]
  buffer_load_dwordx4 v[56:59], v3, s[20:23], s48 offen offset:1024 sc1
  v_mfma_f32_32x32x16_bf16 v[112:127], v[80:83], v[68:71], v[112:127]
  buffer_load_dwordx4 v[60:63], v3, s[20:23], s49 offen offset:1024 sc1
  v_mfma_f32_32x32x16_bf16 v[128:143], v[84:87], v[64:67], v[128:143]
  s_lshl_b32 s44, s77, 14
  s_add_u32 s44, s44, s40
  s_nop 0
  s_add_u32 s44, s44, 49152
  s_add_u32 m0, s43, 94208
  s_add_u32 s45, s44, 8192
  buffer_load_dwordx4 v2, s[24:27], s44 offen lds
  v_mfma_f32_32x32x16_bf16 v[144:159], v[84:87], v[68:71], v[144:159]
  s_add_u32 m0, s43, 95232
  s_nop 0
  buffer_load_dwordx4 v2, s[24:27], s45 offen lds
  s_waitcnt vmcnt(23)
  ds_read_b64_tr_b16 v[80:81], v232 offset:53248
  ds_read_b64_tr_b16 v[82:83], v232 offset:54272
  ds_read_b64_tr_b16 v[84:85], v233 offset:53248
  ds_read_b64_tr_b16 v[86:87], v233 offset:54272
  s_waitcnt lgkmcnt(4)
  v_mfma_f32_32x32x16_bf16 v[96:111], v[88:91], v[72:75], v[96:111]
  buffer_load_dwordx4 v[64:67], v3, s[20:23], s48 offen offset:2048 sc1
  v_mfma_f32_32x32x16_bf16 v[112:127], v[88:91], v[76:79], v[112:127]
  buffer_load_dwordx4 v[68:71], v3, s[20:23], s49 offen offset:2048 sc1
  v_mfma_f32_32x32x16_bf16 v[128:143], v[92:95], v[72:75], v[128:143]
  s_lshl_b32 s44, s78, 14
  s_add_u32 s44, s44, s40
  s_nop 0
  s_add_u32 m0, s43, 102400
  s_add_u32 s45, s44, 8192
  buffer_load_dwordx4 v2, s[24:27], s44 offen lds
  v_mfma_f32_32x32x16_bf16 v[144:159], v[92:95], v[76:79], v[144:159]
  s_add_u32 m0, s43, 103424
  s_nop 0
  buffer_load_dwordx4 v2, s[24:27], s45 offen lds
  s_waitcnt vmcnt(23)
  ds_read_b64_tr_b16 v[88:89], v4 offset:0
  ds_read_b64_tr_b16 v[90:91], v4 offset:1024
  ds_read_b64_tr_b16 v[92:93], v5 offset:0
  ds_read_b64_tr_b16 v[94:95], v5 offset:1024
  s_waitcnt lgkmcnt(4)
  v_mfma_f32_32x32x16_bf16 v[96:111], v[80:83], v[16:19], v[96:111]
  buffer_load_dwordx4 v[72:75], v3, s[20:23], s48 offen offset:3072 sc1
  v_mfma_f32_32x32x16_bf16 v[112:127], v[80:83], v[20:23], v[112:127]
  buffer_load_dwordx4 v[76:79], v3, s[20:23], s49 offen offset:3072 sc1
  v_mfma_f32_32x32x16_bf16 v[128:143], v[84:87], v[16:19], v[128:143]
  s_lshl_b32 s44, s78, 14
  s_add_u32 s44, s44, s40
  s_nop 0
  s_add_u32 s44, s44, 16384
  s_add_u32 m0, s43, 110592
  s_add_u32 s45, s44, 8192
  buffer_load_dwordx4 v2, s[24:27], s44 offen lds
  v_mfma_f32_32x32x16_bf16 v[144:159], v[84:87], v[20:23], v[144:159]
  s_add_u32 m0, s43, 111616
  s_nop 0
  buffer_load_dwordx4 v2, s[24:27], s45 offen lds
  s_waitcnt vmcnt(22)
  ds_read_b64_tr_b16 v[80:81], v4 offset:8192
  ds_read_b64_tr_b16 v[82:83], v4 offset:9216
  ds_read_b64_tr_b16 v[84:85], v5 offset:8192
  ds_read_b64_tr_b16 v[86:87], v5 offset:9216
  s_waitcnt lgkmcnt(4)
  v_mfma_f32_32x32x16_bf16 v[96:111], v[88:91], v[24:27], v[96:111]
  s_lshl_b32 s48, s77, 10
  s_add_u32 s49, s48, s65
  s_add_u32 s48, s48, s64
  buffer_load_dwordx4 v[16:19], v3, s[20:23], s48 offen offset:0 sc1
  v_mfma_f32_32x32x16_bf16 v[112:127], v[88:91], v[28:31], v[112:127]
  buffer_load_dwordx4 v[20:23], v3, s[20:23], s49 offen offset:0 sc1
  v_mfma_f32_32x32x16_bf16 v[128:143], v[92:95], v[24:27], v[128:143]
  s_lshl_b32 s44, s78, 14
  s_add_u32 s44, s44, s40
  s_add_u32 s44, s44, 32768
  s_add_u32 m0, s43, 118784
  s_add_u32 s45, s44, 8192
  buffer_load_dwordx4 v2, s[24:27], s44 offen lds
  v_mfma_f32_32x32x16_bf16 v[144:159], v[92:95], v[28:31], v[144:159]
  s_add_u32 m0, s43, 119808
  s_nop 0
  buffer_load_dwordx4 v2, s[24:27], s45 offen lds
  s_waitcnt vmcnt(22)
  ds_read_b64_tr_b16 v[88:89], v232 offset:61440
  ds_read_b64_tr_b16 v[90:91], v232 offset:62464
  ds_read_b64_tr_b16 v[92:93], v233 offset:61440
  ds_read_b64_tr_b16 v[94:95], v233 offset:62464
  s_waitcnt lgkmcnt(4)
  v_mfma_f32_32x32x16_bf16 v[96:111], v[80:83], v[32:35], v[96:111]
  buffer_load_dwordx4 v[24:27], v3, s[20:23], s48 offen offset:1024 sc1
  v_mfma_f32_32x32x16_bf16 v[112:127], v[80:83], v[36:39], v[112:127]
  buffer_load_dwordx4 v[28:31], v3, s[20:23], s49 offen offset:1024 sc1
  v_mfma_f32_32x32x16_bf16 v[128:143], v[84:87], v[32:35], v[128:143]
  s_lshl_b32 s44, s78, 14
  s_add_u32 s44, s44, s40
  s_add_u32 s44, s44, 49152
  s_add_u32 m0, s43, 0
  s_add_u32 s45, s44, 8192
  buffer_load_dwordx4 v2, s[24:27], s44 offen lds
  v_mfma_f32_32x32x16_bf16 v[144:159], v[84:87], v[36:39], v[144:159]
  s_add_u32 m0, s43, 1024
  s_nop 0
  buffer_load_dwordx4 v2, s[24:27], s45 offen lds
  s_waitcnt vmcnt(22)
  ds_read_b64_tr_b16 v[80:81], v234 offset:4096
  ds_read_b64_tr_b16 v[82:83], v234 offset:5120
  ds_read_b64_tr_b16 v[84:85], v235 offset:4096
  ds_read_b64_tr_b16 v[86:87], v235 offset:5120
  s_waitcnt lgkmcnt(4)
  v_mfma_f32_32x32x16_bf16 v[96:111], v[88:91], v[40:43], v[96:111]
  buffer_load_dwordx4 v[32:35], v3, s[20:23], s48 offen offset:2048 sc1
  v_mfma_f32_32x32x16_bf16 v[112:127], v[88:91], v[44:47], v[112:127]
  buffer_load_dwordx4 v[36:39], v3, s[20:23], s49 offen offset:2048 sc1
  v_mfma_f32_32x32x16_bf16 v[128:143], v[92:95], v[40:43], v[128:143]
  s_lshl_b32 s44, s79, 14
  s_add_u32 s44, s44, s40
  s_nop 0
  s_add_u32 m0, s43, 8192
  s_add_u32 s45, s44, 8192
  buffer_load_dwordx4 v2, s[24:27], s44 offen lds
  v_mfma_f32_32x32x16_bf16 v[144:159], v[92:95], v[44:47], v[144:159]
  s_add_u32 m0, s43, 9216
  s_nop 0
  buffer_load_dwordx4 v2, s[24:27], s45 offen lds
  s_waitcnt vmcnt(22)
  ds_read_b64_tr_b16 v[88:89], v234 offset:12288
  ds_read_b64_tr_b16 v[90:91], v234 offset:13312
  ds_read_b64_tr_b16 v[92:93], v235 offset:12288
  ds_read_b64_tr_b16 v[94:95], v235 offset:13312
  s_waitcnt lgkmcnt(4)
  v_mfma_f32_32x32x16_bf16 v[96:111], v[80:83], v[48:51], v[96:111]
  buffer_load_dwordx4 v[40:43], v3, s[20:23], s48 offen offset:3072 sc1
  v_mfma_f32_32x32x16_bf16 v[112:127], v[80:83], v[52:55], v[112:127]
  buffer_load_dwordx4 v[44:47], v3, s[20:23], s49 offen offset:3072 sc1
  v_mfma_f32_32x32x16_bf16 v[128:143], v[84:87], v[48:51], v[128:143]
  s_lshl_b32 s44, s79, 14
  s_add_u32 s44, s44, s40
  s_nop 0
  s_add_u32 s44, s44, 16384
  s_add_u32 m0, s43, 126976
  s_add_u32 s45, s44, 8192
  buffer_load_dwordx4 v2, s[24:27], s44 offen lds
  v_mfma_f32_32x32x16_bf16 v[144:159], v[84:87], v[52:55], v[144:159]
  s_add_u32 m0, s43, 128000
  s_nop 0
  buffer_load_dwordx4 v2, s[24:27], s45 offen lds
  s_waitcnt vmcnt(22)
  ds_read_b64_tr_b16 v[80:81], v4 offset:32768
  ds_read_b64_tr_b16 v[82:83], v4 offset:33792
  ds_read_b64_tr_b16 v[84:85], v5 offset:32768
  ds_read_b64_tr_b16 v[86:87], v5 offset:33792
  s_waitcnt lgkmcnt(4)
  v_mfma_f32_32x32x16_bf16 v[96:111], v[88:91], v[56:59], v[96:111]
  s_lshl_b32 s48, s78, 10
  s_add_u32 s49, s48, s65
  s_add_u32 s48, s48, s64
  buffer_load_dwordx4 v[48:51], v3, s[20:23], s48 offen offset:0 sc1
  v_mfma_f32_32x32x16_bf16 v[112:127], v[88:91], v[60:63], v[112:127]
  buffer_load_dwordx4 v[52:55], v3, s[20:23], s49 offen offset:0 sc1
  v_mfma_f32_32x32x16_bf16 v[128:143], v[92:95], v[56:59], v[128:143]
  s_lshl_b32 s44, s79, 14
  s_add_u32 s44, s44, s40
  s_add_u32 s44, s44, 32768
  s_add_u32 m0, s43, 135168
  s_add_u32 s45, s44, 8192
  buffer_load_dwordx4 v2, s[24:27], s44 offen lds
  v_mfma_f32_32x32x16_bf16 v[144:159], v[92:95], v[60:63], v[144:159]
  s_add_u32 m0, s43, 136192
  s_nop 0
  buffer_load_dwordx4 v2, s[24:27], s45 offen lds
  s_waitcnt vmcnt(22)
  ds_read_b64_tr_b16 v[88:89], v4 offset:40960
  ds_read_b64_tr_b16 v[90:91], v4 offset:41984
  ds_read_b64_tr_b16 v[92:93], v5 offset:40960
  ds_read_b64_tr_b16 v[94:95], v5 offset:41984
  s_waitcnt lgkmcnt(4)
  v_mfma_f32_32x32x16_bf16 v[96:111], v[80:83], v[64:67], v[96:111]
  buffer_load_dwordx4 v[56:59], v3, s[20:23], s48 offen offset:1024 sc1
  v_mfma_f32_32x32x16_bf16 v[112:127], v[80:83], v[68:71], v[112:127]
  buffer_load_dwordx4 v[60:63], v3, s[20:23], s49 offen offset:1024 sc1
  v_mfma_f32_32x32x16_bf16 v[128:143], v[84:87], v[64:67], v[128:143]
  s_lshl_b32 s44, s79, 14
  s_add_u32 s44, s44, s40
  s_nop 0
  s_add_u32 s44, s44, 49152
  s_add_u32 m0, s43, 143360
  s_add_u32 s45, s44, 8192
  buffer_load_dwordx4 v2, s[24:27], s44 offen lds
  v_mfma_f32_32x32x16_bf16 v[144:159], v[84:87], v[68:71], v[144:159]
  s_add_u32 m0, s43, 144384
  s_nop 0
  buffer_load_dwordx4 v2, s[24:27], s45 offen lds
  s_waitcnt vmcnt(22)
  ds_read_b64_tr_b16 v[80:81], v232 offset:4096
  ds_read_b64_tr_b16 v[82:83], v232 offset:5120
  ds_read_b64_tr_b16 v[84:85], v233 offset:4096
  ds_read_b64_tr_b16 v[86:87], v233 offset:5120
  s_waitcnt lgkmcnt(4)
  v_mfma_f32_32x32x16_bf16 v[96:111], v[88:91], v[72:75], v[96:111]
  buffer_load_dwordx4 v[64:67], v3, s[20:23], s48 offen offset:2048 sc1
  v_mfma_f32_32x32x16_bf16 v[112:127], v[88:91], v[76:79], v[112:127]
  buffer_load_dwordx4 v[68:71], v3, s[20:23], s49 offen offset:2048 sc1
  v_mfma_f32_32x32x16_bf16 v[128:143], v[92:95], v[72:75], v[128:143]
  s_add_u32 s44, s42, 0
  s_add_u32 m0, s43, 32768
  s_add_u32 s45, s44, 8192
  buffer_load_dwordx4 v2, s[28:31], s44 offen lds
  v_mfma_f32_32x32x16_bf16 v[144:159], v[92:95], v[76:79], v[144:159]
  s_add_u32 m0, s43, 33792
  s_nop 0
  buffer_load_dwordx4 v2, s[28:31], s45 offen lds
  s_waitcnt vmcnt(22)
  ds_read_b64_tr_b16 v[88:89], v232 offset:12288
  ds_read_b64_tr_b16 v[90:91], v232 offset:13312
  ds_read_b64_tr_b16 v[92:93], v233 offset:12288
  ds_read_b64_tr_b16 v[94:95], v233 offset:13312
  s_waitcnt lgkmcnt(4)
  v_mfma_f32_32x32x16_bf16 v[96:111], v[80:83], v[16:19], v[96:111]
  buffer_load_dwordx4 v[72:75], v3, s[20:23], s48 offen offset:3072 sc1
  v_mfma_f32_32x32x16_bf16 v[112:127], v[80:83], v[20:23], v[112:127]
  buffer_load_dwordx4 v[76:79], v3, s[20:23], s49 offen offset:3072 sc1
  v_mfma_f32_32x32x16_bf16 v[128:143], v[84:87], v[16:19], v[128:143]
  s_nop 0
  s_add_u32 s44, s42, 16384
  s_add_u32 m0, s43, 40960
  s_add_u32 s45, s44, 8192
  buffer_load_dwordx4 v2, s[28:31], s44 offen lds
  v_mfma_f32_32x32x16_bf16 v[144:159], v[84:87], v[20:23], v[144:159]
  s_add_u32 m0, s43, 41984
  s_nop 0
  buffer_load_dwordx4 v2, s[28:31], s45 offen lds
  s_waitcnt vmcnt(22)
  ds_read_b64_tr_b16 v[80:81], v232 offset:20480
  ds_read_b64_tr_b16 v[82:83], v232 offset:21504
  ds_read_b64_tr_b16 v[84:85], v233 offset:20480
  ds_read_b64_tr_b16 v[86:87], v233 offset:21504
  s_waitcnt lgkmcnt(4)
  v_mfma_f32_32x32x16_bf16 v[96:111], v[88:91], v[24:27], v[96:111]
  s_lshl_b32 s48, s79, 10
  s_add_u32 s49, s48, s65
  s_add_u32 s48, s48, s64
  buffer_load_dwordx4 v[16:19], v3, s[20:23], s48 offen offset:0 sc1
  v_mfma_f32_32x32x16_bf16 v[112:127], v[88:91], v[28:31], v[112:127]
  buffer_load_dwordx4 v[20:23], v3, s[20:23], s49 offen offset:0 sc1
  v_mfma_f32_32x32x16_bf16 v[128:143], v[92:95], v[24:27], v[128:143]
  s_add_u32 s44, s42, 32768
  s_add_u32 m0, s43, 69632
  s_add_u32 s45, s44, 8192
  buffer_load_dwordx4 v2, s[28:31], s44 offen lds
  v_mfma_f32_32x32x16_bf16 v[144:159], v[92:95], v[28:31], v[144:159]
  s_add_u32 m0, s43, 70656
  s_nop 0
  buffer_load_dwordx4 v2, s[28:31], s45 offen lds
  s_waitcnt vmcnt(22)
  ds_read_b64_tr_b16 v[88:89], v232 offset:28672
  ds_read_b64_tr_b16 v[90:91], v232 offset:29696
  ds_read_b64_tr_b16 v[92:93], v233 offset:28672
  ds_read_b64_tr_b16 v[94:95], v233 offset:29696
  s_waitcnt lgkmcnt(4)
  v_mfma_f32_32x32x16_bf16 v[96:111], v[80:83], v[32:35], v[96:111]
  buffer_load_dwordx4 v[24:27], v3, s[20:23], s48 offen offset:1024 sc1
  v_mfma_f32_32x32x16_bf16 v[112:127], v[80:83], v[36:39], v[112:127]
  buffer_load_dwordx4 v[28:31], v3, s[20:23], s49 offen offset:1024 sc1
  v_mfma_f32_32x32x16_bf16 v[128:143], v[84:87], v[32:35], v[128:143]
  s_nop 0
  s_add_u32 s44, s42, 49152
  s_add_u32 m0, s43, 77824
  s_add_u32 s45, s44, 8192
  buffer_load_dwordx4 v2, s[28:31], s44 offen lds
  v_mfma_f32_32x32x16_bf16 v[144:159], v[84:87], v[36:39], v[144:159]
  s_add_u32 m0, s43, 78848
  s_nop 0
  buffer_load_dwordx4 v2, s[28:31], s45 offen lds
  s_waitcnt vmcnt(22)
  ds_read_b64_tr_b16 v[80:81], v232 offset:36864
  ds_read_b64_tr_b16 v[82:83], v232 offset:37888
  ds_read_b64_tr_b16 v[84:85], v233 offset:36864
  ds_read_b64_tr_b16 v[86:87], v233 offset:37888
  s_waitcnt lgkmcnt(4)
  v_mfma_f32_32x32x16_bf16 v[96:111], v[88:91], v[40:43], v[96:111]
  buffer_load_dwordx4 v[32:35], v3, s[20:23], s48 offen offset:2048 sc1
  v_mfma_f32_32x32x16_bf16 v[112:127], v[88:91], v[44:47], v[112:127]
  buffer_load_dwordx4 v[36:39], v3, s[20:23], s49 offen offset:2048 sc1
  v_mfma_f32_32x32x16_bf16 v[128:143], v[92:95], v[40:43], v[128:143]
  s_nop 0
  s_add_u32 s44, s42, 65536
  s_add_u32 m0, s43, 86016
  s_add_u32 s45, s44, 8192
  buffer_load_dwordx4 v2, s[28:31], s44 offen lds
  v_mfma_f32_32x32x16_bf16 v[144:159], v[92:95], v[44:47], v[144:159]
  s_add_u32 m0, s43, 87040
  s_nop 0
  buffer_load_dwordx4 v2, s[28:31], s45 offen lds
  s_waitcnt vmcnt(22)
  ds_read_b64_tr_b16 v[88:89], v232 offset:45056
  ds_read_b64_tr_b16 v[90:91], v232 offset:46080
  ds_read_b64_tr_b16 v[92:93], v233 offset:45056
  ds_read_b64_tr_b16 v[94:95], v233 offset:46080
  s_waitcnt lgkmcnt(4)
  s_xor_b32 s57, s15, 1
  s_lshl_b32 s57, s57, 11
  v_add_u32 v237, s57, v3
  v_add_u32 v238, 0x10000, v237
  v_add_u32 v239, 0x20000, v237
  s_xor_b32 s57, s15, 2
  s_lshl_b32 s57, s57, 11
  v_add_u32_e64 v240, s57, v3
  v_add_u32 v241, 0x10000, v240
  v_add_u32 v242, 0x20000, v240
  s_xor_b32 s57, s15, 3
  s_lshl_b32 s57, s57, 11
  v_add_u32_e64 v243, s57, v3
  v_add_u32 v244, 0x10000, v243
  v_add_u32 v245, 0x20000, v243
  v_mfma_f32_32x32x16_bf16 v[96:111], v[80:83], v[48:51], v[96:111]
  buffer_load_dwordx4 v[40:43], v3, s[20:23], s48 offen offset:3072 sc1
  v_mfma_f32_32x32x16_bf16 v[112:127], v[80:83], v[52:55], v[112:127]
  buffer_load_dwordx4 v[44:47], v3, s[20:23], s49 offen offset:3072 sc1
  v_mfma_f32_32x32x16_bf16 v[128:143], v[84:87], v[48:51], v[128:143]
  s_add_u32 s44, s42, 81920
  s_add_u32 m0, s43, 94208
  s_add_u32 s45, s44, 8192
  buffer_load_dwordx4 v2, s[28:31], s44 offen lds
  v_mfma_f32_32x32x16_bf16 v[144:159], v[84:87], v[52:55], v[144:159]
  s_add_u32 m0, s43, 95232
  s_nop 0
  buffer_load_dwordx4 v2, s[28:31], s45 offen lds
  s_waitcnt vmcnt(22)
  ds_read_b64_tr_b16 v[80:81], v232 offset:53248
  ds_read_b64_tr_b16 v[82:83], v232 offset:54272
  ds_read_b64_tr_b16 v[84:85], v233 offset:53248
  ds_read_b64_tr_b16 v[86:87], v233 offset:54272
  s_waitcnt lgkmcnt(4)
  v_mfma_f32_32x32x16_bf16 v[96:111], v[88:91], v[56:59], v[96:111]
  v_mfma_f32_32x32x16_bf16 v[112:127], v[88:91], v[60:63], v[112:127]
  s_nop 0
  s_add_u32 s44, s42, 98304
  s_add_u32 m0, s43, 102400
  s_add_u32 s45, s44, 8192
  buffer_load_dwordx4 v2, s[28:31], s44 offen lds
  v_mfma_f32_32x32x16_bf16 v[128:143], v[92:95], v[56:59], v[128:143]
  v_mfma_f32_32x32x16_bf16 v[144:159], v[92:95], v[60:63], v[144:159]
  s_add_u32 m0, s43, 103424
  s_nop 0
  buffer_load_dwordx4 v2, s[28:31], s45 offen lds
  s_waitcnt vmcnt(20)
  ds_read_b64_tr_b16 v[88:89], v4 offset:0
  ds_read_b64_tr_b16 v[90:91], v4 offset:1024
  ds_read_b64_tr_b16 v[92:93], v5 offset:0
  ds_read_b64_tr_b16 v[94:95], v5 offset:1024
  s_waitcnt lgkmcnt(4)
  v_mfma_f32_32x32x16_bf16 v[96:111], v[80:83], v[64:67], v[96:111]
  v_mfma_f32_32x32x16_bf16 v[112:127], v[80:83], v[68:71], v[112:127]
  s_nop 0
  s_add_u32 s44, s42, 114688
  s_add_u32 m0, s43, 110592
  s_add_u32 s45, s44, 8192
  buffer_load_dwordx4 v2, s[28:31], s44 offen lds
  v_mfma_f32_32x32x16_bf16 v[128:143], v[84:87], v[64:67], v[128:143]
  v_mfma_f32_32x32x16_bf16 v[144:159], v[84:87], v[68:71], v[144:159]
  s_add_u32 m0, s43, 111616
  s_nop 0
  buffer_load_dwordx4 v2, s[28:31], s45 offen lds
  s_waitcnt vmcnt(18)
  ds_read_b64_tr_b16 v[80:81], v4 offset:8192
  ds_read_b64_tr_b16 v[82:83], v4 offset:9216
  ds_read_b64_tr_b16 v[84:85], v5 offset:8192
  ds_read_b64_tr_b16 v[86:87], v5 offset:9216
  s_waitcnt lgkmcnt(4)
  buffer_load_dwordx4 v[8:11], v224, s[32:35], s54 offen
  buffer_load_dwordx4 v[12:15], v224, s[32:35], s54 offen offset:32
  v_mfma_f32_32x32x16_bf16 v[96:111], v[88:91], v[72:75], v[96:111]
  v_mfma_f32_32x32x16_bf16 v[112:127], v[88:91], v[76:79], v[112:127]
  v_mfma_f32_32x32x16_bf16 v[128:143], v[92:95], v[72:75], v[128:143]
  v_mfma_f32_32x32x16_bf16 v[144:159], v[92:95], v[76:79], v[144:159]
  s_waitcnt vmcnt(16)
  ds_read_b64_tr_b16 v[88:89], v232 offset:61440
  ds_read_b64_tr_b16 v[90:91], v232 offset:62464
  ds_read_b64_tr_b16 v[92:93], v233 offset:61440
  ds_read_b64_tr_b16 v[94:95], v233 offset:62464
  s_waitcnt lgkmcnt(4)
  v_mfma_f32_32x32x16_bf16 v[96:111], v[80:83], v[16:19], v[96:111]
  v_mfma_f32_32x32x16_bf16 v[112:127], v[80:83], v[20:23], v[112:127]
  v_mfma_f32_32x32x16_bf16 v[128:143], v[84:87], v[16:19], v[128:143]
  v_mfma_f32_32x32x16_bf16 v[144:159], v[84:87], v[20:23], v[144:159]
  s_waitcnt vmcnt(12)
  ds_read_b64_tr_b16 v[80:81], v234 offset:4096
  ds_read_b64_tr_b16 v[82:83], v234 offset:5120
  ds_read_b64_tr_b16 v[84:85], v235 offset:4096
  ds_read_b64_tr_b16 v[86:87], v235 offset:5120
  s_waitcnt lgkmcnt(4)
  s_lshl_b32 s55, s50, 12
  s_lshl_b32 s57, s15, 10
  s_add_u32 s55, s55, s57
  s_add_u32 s55, s55, 17825792
  buffer_load_dword v228, v227, s[20:23], s55 offen sc1
  v_mfma_f32_32x32x16_bf16 v[96:111], v[88:91], v[24:27], v[96:111]
  v_mfma_f32_32x32x16_bf16 v[112:127], v[88:91], v[28:31], v[112:127]
  v_mfma_f32_32x32x16_bf16 v[128:143], v[92:95], v[24:27], v[128:143]
  v_mfma_f32_32x32x16_bf16 v[144:159], v[92:95], v[28:31], v[144:159]
  s_waitcnt vmcnt(9)
  ds_read_b64_tr_b16 v[88:89], v234 offset:12288
  ds_read_b64_tr_b16 v[90:91], v234 offset:13312
  ds_read_b64_tr_b16 v[92:93], v235 offset:12288
  ds_read_b64_tr_b16 v[94:95], v235 offset:13312
  s_waitcnt lgkmcnt(4)
  v_mfma_f32_32x32x16_bf16 v[96:111], v[80:83], v[32:35], v[96:111]
  v_mfma_f32_32x32x16_bf16 v[112:127], v[80:83], v[36:39], v[112:127]
  v_mfma_f32_32x32x16_bf16 v[128:143], v[84:87], v[32:35], v[128:143]
  v_mfma_f32_32x32x16_bf16 v[144:159], v[84:87], v[36:39], v[144:159]
  ds_read_b64_tr_b16 v[80:81], v4 offset:32768
  ds_read_b64_tr_b16 v[82:83], v4 offset:33792
  ds_read_b64_tr_b16 v[84:85], v5 offset:32768
  ds_read_b64_tr_b16 v[86:87], v5 offset:33792
  s_waitcnt lgkmcnt(4)
  v_mfma_f32_32x32x16_bf16 v[96:111], v[88:91], v[40:43], v[96:111]
  v_mfma_f32_32x32x16_bf16 v[112:127], v[88:91], v[44:47], v[112:127]
  v_mfma_f32_32x32x16_bf16 v[128:143], v[92:95], v[40:43], v[128:143]
  v_mfma_f32_32x32x16_bf16 v[144:159], v[92:95], v[44:47], v[144:159]
  s_nop 7
  s_nop 1
  ds_write_b128 v6, v[112:115] offset:53248
  ds_write_b128 v6, v[116:119] offset:54272
  ds_write_b128 v236, v[120:123] offset:0
  ds_write_b128 v236, v[124:127] offset:1024
  ds_write_b128 v236, v[128:131] offset:8192
  ds_write_b128 v236, v[132:135] offset:9216
  ds_write_b128 v6, v[136:139] offset:61440
  ds_write_b128 v6, v[140:143] offset:62464
  ds_write_b128 v7, v[144:147] offset:4096
  ds_write_b128 v7, v[148:151] offset:5120
  ds_write_b128 v7, v[152:155] offset:12288
  ds_write_b128 v7, v[156:159] offset:13312
  s_waitcnt vmcnt(0)
  v_cmp_eq_u32 vcc, s80, v228
  s_mov_b32 s46, 0
  s_cmp_eq_u64 vcc, -1
  s_cbranch_scc1 M_OOK
  s_mov_b32 s46, 1
  buffer_load_dword v228, v227, s[20:23], s55 offen sc1
  s_call_b64 s[70:71], M_GATE
  s_waitcnt vmcnt(0)
  v_cmp_eq_u32 vcc, s80, v228
  s_mov_b32 s56, 0
  s_cmp_eq_u64 vcc, -1
  s_cbranch_scc1 MO_OK
MO_P:
  s_sleep 8
  buffer_load_dword v228, v227, s[20:23], s55 offen sc1
  s_add_u32 s56, s56, 1
  s_waitcnt vmcnt(0)
  v_cmp_eq_u32 vcc, s80, v228
  s_cmp_gt_u32 s56, 20000
  s_cbranch_scc1 MO_OK
  s_cmp_eq_u64 vcc, -1
  s_cbranch_scc0 MO_P
MO_OK:
M_OOK:
  s_add_u32 s48, s67, 0
  s_add_u32 s49, s53, 0
  buffer_load_dwordx4 v[48:51], v3, s[20:23], s48 offen offset:0 sc1
  buffer_load_dwordx4 v[52:55], v3, s[20:23], s49 offen offset:0 sc1
  buffer_load_dwordx4 v[56:59], v3, s[20:23], s48 offen offset:1024 sc1
  buffer_load_dwordx4 v[60:63], v3, s[20:23], s49 offen offset:1024 sc1
  buffer_load_dwordx4 v[64:67], v3, s[20:23], s48 offen offset:2048 sc1
  buffer_load_dwordx4 v[68:71], v3, s[20:23], s49 offen offset:2048 sc1
  buffer_load_dwordx4 v[72:75], v3, s[20:23], s48 offen offset:3072 sc1
  buffer_load_dwordx4 v[76:79], v3, s[20:23], s49 offen offset:3072 sc1
  s_add_u32 s48, s67, 4096
  s_add_u32 s49, s53, 4096
  buffer_load_dwordx4 v[16:19], v3, s[20:23], s48 offen offset:0 sc1
  buffer_load_dwordx4 v[20:23], v3, s[20:23], s49 offen offset:0 sc1
  buffer_load_dwordx4 v[24:27], v3, s[20:23], s48 offen offset:1024 sc1
  buffer_load_dwordx4 v[28:31], v3, s[20:23], s49 offen offset:1024 sc1
  buffer_load_dwordx4 v[32:35], v3, s[20:23], s48 offen offset:2048 sc1
  buffer_load_dwordx4 v[36:39], v3, s[20:23], s49 offen offset:2048 sc1
  buffer_load_dwordx4 v[40:43], v3, s[20:23], s48 offen offset:3072 sc1
  buffer_load_dwordx4 v[44:47], v3, s[20:23], s49 offen offset:3072 sc1
  s_cmp_eq_u32 s46, 1
  s_cbranch_scc1 M_GDONE
  s_call_b64 s[70:71], M_GATE
M_GDONE:
  s_waitcnt vmcnt(14)
  s_waitcnt vmcnt(12)
  ds_read_b64_tr_b16 v[88:89], v4 offset:40960
  ds_read_b64_tr_b16 v[90:91], v4 offset:41984
  ds_read_b64_tr_b16 v[92:93], v5 offset:40960
  ds_read_b64_tr_b16 v[94:95], v5 offset:41984
  s_waitcnt lgkmcnt(4)
  v_mfma_f32_32x32x16_bf16 v[160:175], v[80:83], v[48:51], 0
  v_mfma_f32_32x32x16_bf16 v[176:191], v[80:83], v[52:55], 0
  v_mfma_f32_32x32x16_bf16 v[192:207], v[84:87], v[48:51], 0
  v_mfma_f32_32x32x16_bf16 v[208:223], v[84:87], v[52:55], 0
  s_waitcnt vmcnt(10)
  ds_read_b64_tr_b16 v[80:81], v232 offset:4096
  ds_read_b64_tr_b16 v[82:83], v232 offset:5120
  ds_read_b64_tr_b16 v[84:85], v233 offset:4096
  ds_read_b64_tr_b16 v[86:87], v233 offset:5120
  s_waitcnt lgkmcnt(4)
  v_mfma_f32_32x32x16_bf16 v[160:175], v[88:91], v[56:59], v[160:175]
  v_mfma_f32_32x32x16_bf16 v[176:191], v[88:91], v[60:63], v[176:191]
  v_mfma_f32_32x32x16_bf16 v[192:207], v[92:95], v[56:59], v[192:207]
  v_mfma_f32_32x32x16_bf16 v[208:223], v[92:95], v[60:63], v[208:223]
  s_waitcnt vmcnt(8)
  ds_read_b64_tr_b16 v[88:89], v232 offset:12288
  ds_read_b64_tr_b16 v[90:91], v232 offset:13312
  ds_read_b64_tr_b16 v[92:93], v233 offset:12288
  ds_read_b64_tr_b16 v[94:95], v233 offset:13312
  s_waitcnt lgkmcnt(4)
  v_mfma_f32_32x32x16_bf16 v[160:175], v[80:83], v[64:67], v[160:175]
  v_mfma_f32_32x32x16_bf16 v[176:191], v[80:83], v[68:71], v[176:191]
  v_mfma_f32_32x32x16_bf16 v[192:207], v[84:87], v[64:67], v[192:207]
  v_mfma_f32_32x32x16_bf16 v[208:223], v[84:87], v[68:71], v[208:223]
  s_waitcnt vmcnt(6)
  ds_read_b64_tr_b16 v[80:81], v232 offset:20480
  ds_read_b64_tr_b16 v[82:83], v232 offset:21504
  ds_read_b64_tr_b16 v[84:85], v233 offset:20480
  ds_read_b64_tr_b16 v[86:87], v233 offset:21504
  s_waitcnt lgkmcnt(4)
  v_mfma_f32_32x32x16_bf16 v[160:175], v[88:91], v[72:75], v[160:175]
  v_mfma_f32_32x32x16_bf16 v[176:191], v[88:91], v[76:79], v[176:191]
  v_mfma_f32_32x32x16_bf16 v[192:207], v[92:95], v[72:75], v[192:207]
  v_mfma_f32_32x32x16_bf16 v[208:223], v[92:95], v[76:79], v[208:223]
  s_waitcnt vmcnt(4)
  ds_read_b64_tr_b16 v[88:89], v232 offset:28672
  ds_read_b64_tr_b16 v[90:91], v232 offset:29696
  ds_read_b64_tr_b16 v[92:93], v233 offset:28672
  ds_read_b64_tr_b16 v[94:95], v233 offset:29696
  s_waitcnt lgkmcnt(4)
  v_mfma_f32_32x32x16_bf16 v[160:175], v[80:83], v[16:19], v[160:175]
  v_mfma_f32_32x32x16_bf16 v[176:191], v[80:83], v[20:23], v[176:191]
  v_mfma_f32_32x32x16_bf16 v[192:207], v[84:87], v[16:19], v[192:207]
  v_mfma_f32_32x32x16_bf16 v[208:223], v[84:87], v[20:23], v[208:223]
  s_waitcnt vmcnt(2)
  ds_read_b64_tr_b16 v[80:81], v232 offset:36864
  ds_read_b64_tr_b16 v[82:83], v232 offset:37888
  ds_read_b64_tr_b16 v[84:85], v233 offset:36864
  ds_read_b64_tr_b16 v[86:87], v233 offset:37888
  s_waitcnt lgkmcnt(4)
  v_mfma_f32_32x32x16_bf16 v[160:175], v[88:91], v[24:27], v[160:175]
  v_mfma_f32_32x32x16_bf16 v[176:191], v[88:91], v[28:31], v[176:191]
  v_mfma_f32_32x32x16_bf16 v[192:207], v[92:95], v[24:27], v[192:207]
  v_mfma_f32_32x32x16_bf16 v[208:223], v[92:95], v[28:31], v[208:223]
  s_waitcnt vmcnt(0)
  ds_read_b64_tr_b16 v[88:89], v232 offset:45056
  ds_read_b64_tr_b16 v[90:91], v232 offset:46080
  ds_read_b64_tr_b16 v[92:93], v233 offset:45056
  ds_read_b64_tr_b16 v[94:95], v233 offset:46080
  s_waitcnt lgkmcnt(4)
  v_mfma_f32_32x32x16_bf16 v[160:175], v[80:83], v[32:35], v[160:175]
  v_mfma_f32_32x32x16_bf16 v[176:191], v[80:83], v[36:39], v[176:191]
  v_mfma_f32_32x32x16_bf16 v[192:207], v[84:87], v[32:35], v[192:207]
  v_mfma_f32_32x32x16_bf16 v[208:223], v[84:87], v[36:39], v[208:223]
  s_waitcnt lgkmcnt(0)
  v_mfma_f32_32x32x16_bf16 v[160:175], v[88:91], v[40:43], v[160:175]
  v_mfma_f32_32x32x16_bf16 v[176:191], v[88:91], v[44:47], v[176:191]
  v_mfma_f32_32x32x16_bf16 v[192:207], v[92:95], v[40:43], v[192:207]
  v_mfma_f32_32x32x16_bf16 v[208:223], v[92:95], v[44:47], v[208:223]
  s_nop 7
  s_nop 1
  ds_write_b128 v236, v[176:179] offset:32768
  ds_write_b128 v236, v[180:183] offset:33792
  ds_write_b128 v236, v[184:187] offset:40960
  ds_write_b128 v236, v[188:191] offset:41984
  ds_write_b128 v6, v[192:195] offset:4096
  ds_write_b128 v6, v[196:199] offset:5120
  ds_write_b128 v6, v[200:203] offset:12288
  ds_write_b128 v6, v[204:207] offset:13312
  ds_write_b128 v6, v[208:211] offset:20480
  ds_write_b128 v6, v[212:215] offset:21504
  ds_write_b128 v6, v[216:219] offset:28672
  ds_write_b128 v6, v[220:223] offset:29696
  s_waitcnt lgkmcnt(0)
  s_barrier
  ds_read_b128 v[176:179], v237 offset:32768
  ds_read_b128 v[180:183], v237 offset:33792
  ds_read_b128 v[184:187], v237 offset:40960
  ds_read_b128 v[188:191], v237 offset:41984
  ds_read_b128 v[192:195], v241 offset:4096
  ds_read_b128 v[196:199], v241 offset:5120
  ds_read_b128 v[200:203], v241 offset:12288
  ds_read_b128 v[204:207], v241 offset:13312
  ds_read_b128 v[208:211], v244 offset:20480
  ds_read_b128 v[212:215], v244 offset:21504
  ds_read_b128 v[216:219], v244 offset:28672
  ds_read_b128 v[220:223], v244 offset:29696
  s_waitcnt lgkmcnt(0)
  v_pk_add_f32 v[160:161], v[160:161], v[176:177]
  v_pk_add_f32 v[192:193], v[192:193], v[208:209]
  v_pk_add_f32 v[162:163], v[162:163], v[178:179]
  v_pk_add_f32 v[194:195], v[194:195], v[210:211]
  v_pk_add_f32 v[164:165], v[164:165], v[180:181]
  v_pk_add_f32 v[196:197], v[196:197], v[212:213]
  v_pk_add_f32 v[166:167], v[166:167], v[182:183]
  v_pk_add_f32 v[198:199], v[198:199], v[214:215]
  v_pk_add_f32 v[168:169], v[168:169], v[184:185]
  v_pk_add_f32 v[200:201], v[200:201], v[216:217]
  v_pk_add_f32 v[170:171], v[170:171], v[186:187]
  v_pk_add_f32 v[202:203], v[202:203], v[218:219]
  v_pk_add_f32 v[172:173], v[172:173], v[188:189]
  v_pk_add_f32 v[204:205], v[204:205], v[220:221]
  v_pk_add_f32 v[174:175], v[174:175], v[190:191]
  v_pk_add_f32 v[206:207], v[206:207], v[222:223]
  v_pk_add_f32 v[160:161], v[160:161], v[192:193]
  v_pk_add_f32 v[162:163], v[162:163], v[194:195]
  v_pk_add_f32 v[164:165], v[164:165], v[196:197]
  v_pk_add_f32 v[166:167], v[166:167], v[198:199]
  v_pk_add_f32 v[168:169], v[168:169], v[200:201]
  v_pk_add_f32 v[170:171], v[170:171], v[202:203]
  v_pk_add_f32 v[172:173], v[172:173], v[204:205]
  v_pk_add_f32 v[174:175], v[174:175], v[206:207]
  v_pk_fma_f32 v[96:97], v[96:97], v[160:161], v[128:129]
  v_pk_fma_f32 v[98:99], v[98:99], v[162:163], v[130:131]
  v_pk_fma_f32 v[100:101], v[100:101], v[164:165], v[132:133]
  v_pk_fma_f32 v[102:103], v[102:103], v[166:167], v[134:135]
  v_pk_fma_f32 v[104:105], v[104:105], v[168:169], v[136:137]
  v_pk_fma_f32 v[106:107], v[106:107], v[170:171], v[138:139]
  v_pk_fma_f32 v[108:109], v[108:109], v[172:173], v[140:141]
  v_pk_fma_f32 v[110:111], v[110:111], v[174:175], v[142:143]
  v_cvt_pk_bf16_f32 v8, v96, v97
  v_cvt_pk_bf16_f32 v9, v98, v99
  v_cvt_pk_bf16_f32 v10, v100, v101
  v_cvt_pk_bf16_f32 v11, v102, v103
  v_cvt_pk_bf16_f32 v12, v104, v105
  v_cvt_pk_bf16_f32 v13, v106, v107
  v_cvt_pk_bf16_f32 v14, v108, v109
  v_cvt_pk_bf16_f32 v15, v110, v111
  s_nop 1
  v_permlane32_swap_b32 v8, v10
  v_permlane32_swap_b32 v9, v11
  v_permlane32_swap_b32 v12, v14
  v_permlane32_swap_b32 v13, v15
  buffer_store_dwordx4 v[8:11], v224, s[36:39], s54 offen
  buffer_store_dwordx4 v[12:15], v224, s[36:39], s54 offen offset:32
  s_endpgm
M_GATE:
  s_waitcnt lgkmcnt(0)
  s_barrier
  ds_read_b128 v[112:115], v238 offset:53248
  ds_read_b128 v[116:119], v238 offset:54272
  ds_read_b128 v[120:123], v237 offset:0
  ds_read_b128 v[124:127], v237 offset:1024
  ds_read_b128 v[128:131], v240 offset:8192
  ds_read_b128 v[132:135], v240 offset:9216
  ds_read_b128 v[136:139], v241 offset:61440
  ds_read_b128 v[140:143], v241 offset:62464
  ds_read_b128 v[144:147], v245 offset:4096
  ds_read_b128 v[148:151], v245 offset:5120
  ds_read_b128 v[152:155], v245 offset:12288
  ds_read_b128 v[156:159], v245 offset:13312
  v_permlane32_swap_b32 v8, v10
  v_permlane32_swap_b32 v9, v11
  v_permlane32_swap_b32 v12, v14
  v_permlane32_swap_b32 v13, v15
  s_waitcnt lgkmcnt(0)
  s_nop 0
  v_pk_add_f32 v[96:97], v[96:97], v[112:113]
  v_pk_add_f32 v[128:129], v[128:129], v[144:145]
  v_pk_add_f32 v[98:99], v[98:99], v[114:115]
  v_pk_add_f32 v[130:131], v[130:131], v[146:147]
  v_pk_add_f32 v[100:101], v[100:101], v[116:117]
  v_pk_add_f32 v[132:133], v[132:133], v[148:149]
  v_pk_add_f32 v[102:103], v[102:103], v[118:119]
  v_pk_add_f32 v[134:135], v[134:135], v[150:151]
  v_pk_add_f32 v[104:105], v[104:105], v[120:121]
  v_pk_add_f32 v[136:137], v[136:137], v[152:153]
  v_pk_add_f32 v[106:107], v[106:107], v[122:123]
  v_pk_add_f32 v[138:139], v[138:139], v[154:155]
  v_pk_add_f32 v[108:109], v[108:109], v[124:125]
  v_pk_add_f32 v[140:141], v[140:141], v[156:157]
  v_pk_add_f32 v[110:111], v[110:111], v[126:127]
  v_pk_add_f32 v[142:143], v[142:143], v[158:159]
  v_pk_add_f32 v[96:97], v[96:97], v[128:129]
  v_pk_add_f32 v[98:99], v[98:99], v[130:131]
  v_pk_add_f32 v[100:101], v[100:101], v[132:133]
  v_pk_add_f32 v[102:103], v[102:103], v[134:135]
  v_pk_add_f32 v[104:105], v[104:105], v[136:137]
  v_pk_add_f32 v[106:107], v[106:107], v[138:139]
  v_pk_add_f32 v[108:109], v[108:109], v[140:141]
  v_pk_add_f32 v[110:111], v[110:111], v[142:143]
  v_mul_f32 v112, 0xbfb8aa3b, v96
  v_mul_f32 v113, 0xbfb8aa3b, v97
  v_mul_f32 v114, 0xbfb8aa3b, v98
  v_mul_f32 v115, 0xbfb8aa3b, v99
  v_mul_f32 v116, 0xbfb8aa3b, v100
  v_mul_f32 v117, 0xbfb8aa3b, v101
  v_mul_f32 v118, 0xbfb8aa3b, v102
  v_mul_f32 v119, 0xbfb8aa3b, v103
  v_mul_f32 v120, 0xbfb8aa3b, v104
  v_mul_f32 v121, 0xbfb8aa3b, v105
  v_mul_f32 v122, 0xbfb8aa3b, v106
  v_mul_f32 v123, 0xbfb8aa3b, v107
  v_mul_f32 v124, 0xbfb8aa3b, v108
  v_mul_f32 v125, 0xbfb8aa3b, v109
  v_mul_f32 v126, 0xbfb8aa3b, v110
  v_mul_f32 v127, 0xbfb8aa3b, v111
  v_exp_f32 v112, v112
  v_exp_f32 v113, v113
  v_exp_f32 v114, v114
  v_exp_f32 v115, v115
  v_exp_f32 v116, v116
  v_exp_f32 v117, v117
  v_exp_f32 v118, v118
  v_exp_f32 v119, v119
  v_exp_f32 v120, v120
  v_exp_f32 v121, v121
  v_exp_f32 v122, v122
  v_exp_f32 v123, v123
  v_exp_f32 v124, v124
  v_exp_f32 v125, v125
  v_exp_f32 v126, v126
  v_exp_f32 v127, v127
  v_lshlrev_b32_e64 v128, 16, v8
  v_and_b32 v129, 0xffff0000, v8
  v_lshlrev_b32_e64 v130, 16, v9
  v_and_b32 v131, 0xffff0000, v9
  v_lshlrev_b32_e64 v132, 16, v10
  v_and_b32 v133, 0xffff0000, v10
  v_lshlrev_b32_e64 v134, 16, v11
  v_and_b32 v135, 0xffff0000, v11
  v_lshlrev_b32_e64 v136, 16, v12
  v_and_b32 v137, 0xffff0000, v12
  v_lshlrev_b32_e64 v138, 16, v13
  v_and_b32 v139, 0xffff0000, v13
  v_lshlrev_b32_e64 v140, 16, v14
  v_and_b32 v141, 0xffff0000, v14
  v_lshlrev_b32_e64 v142, 16, v15
  v_and_b32 v143, 0xffff0000, v15
  v_add_f32 v112, 1.0, v112
  v_add_f32 v113, 1.0, v113
  v_add_f32 v114, 1.0, v114
  v_add_f32 v115, 1.0, v115
  v_add_f32 v116, 1.0, v116
  v_add_f32 v117, 1.0, v117
  v_add_f32 v118, 1.0, v118
  v_add_f32 v119, 1.0, v119
  v_add_f32 v120, 1.0, v120
  v_add_f32 v121, 1.0, v121
  v_add_f32 v122, 1.0, v122
  v_add_f32 v123, 1.0, v123
  v_add_f32 v124, 1.0, v124
  v_add_f32 v125, 1.0, v125
  v_add_f32 v126, 1.0, v126
  v_add_f32 v127, 1.0, v127
  v_rcp_f32 v112, v112
  v_rcp_f32 v113, v113
  v_rcp_f32 v114, v114
  v_rcp_f32 v115, v115
  v_rcp_f32 v116, v116
  v_rcp_f32 v117, v117
  v_rcp_f32 v118, v118
  v_rcp_f32 v119, v119
  v_rcp_f32 v120, v120
  v_rcp_f32 v121, v121
  v_rcp_f32 v122, v122
  v_rcp_f32 v123, v123
  v_rcp_f32 v124, v124
  v_rcp_f32 v125, v125
  v_rcp_f32 v126, v126
  v_rcp_f32_e64 v127, v127
  s_nop 0
  v_pk_mul_f32 v[96:97], v[96:97], v[112:113]
  v_pk_mul_f32 v[98:99], v[98:99], v[114:115]
  v_pk_mul_f32 v[100:101], v[100:101], v[116:117]
  v_pk_mul_f32 v[102:103], v[102:103], v[118:119]
  v_pk_mul_f32 v[104:105], v[104:105], v[120:121]
  v_pk_mul_f32 v[106:107], v[106:107], v[122:123]
  v_pk_mul_f32 v[108:109], v[108:109], v[124:125]
  v_pk_mul_f32 v[110:111], v[110:111], v[126:127]
  s_setpc_b64 s[70:71]
L_CODE_END:
.section .rodata,"a"
.p2align 6
.amdhsa_kernel recurrent_scan__sliding_block__geglu_ffn__prompt_kernel
  .amdhsa_next_free_vgpr 256
  .amdhsa_next_free_sgpr 102
  .amdhsa_accum_offset 256
  .amdhsa_group_segment_fixed_size 0
  .amdhsa_kernarg_size 80
  .amdhsa_user_sgpr_count 2
  .amdhsa_user_sgpr_kernarg_segment_ptr 1
  .amdhsa_system_sgpr_workgroup_id_x 1
.end_amdhsa_kernel
```
